```python
import torch

def _softmax(x, axis=-1):
    return torch.softmax(x, dim=axis)
def _gelu(x):
    return torch.nn.functional.gelu(x, approximate="tanh")
def _silu(x):
    return torch.nn.functional.silu(x)
def _sigmoid(x):
    return torch.sigmoid(x)
def _layernorm(x, axis=-1, eps=1e-5):
    m = x.mean(dim=axis, keepdim=True)
    v = x.var(dim=axis, keepdim=True, unbiased=False)
    return (x - m) / torch.sqrt(v + eps)
def _scatter_add(tgt, idx, src, axis=0):
    return tgt.clone().index_add_(axis, idx, src)
def _segment_sum(src, seg, n):
    out = torch.zeros((n,) + src.shape[1:], dtype=src.dtype)
    return out.index_add_(0, seg, src)
def _pad(x, pw):
    flat = tuple(v for pair in reversed(pw) for v in pair)
    return torch.nn.functional.pad(x, flat)

kernel_name = 'parallel_sum__softmax_full_mha__moe_arch_mod__prompt'

def setup_inputs():

    _w = (lambda a: (lambda t: t.to(torch.bfloat16) if t.is_floating_point() else t)(torch.as_tensor(a)))
    def _A_setup():
        B, S, D = 1, 2048, 640
        return {
            "x": _w((lambda *s: torch.randn(*s, dtype=torch.bfloat16) * 0.05)(B, S, D)),
            "wqkv": _w((lambda *s: torch.randn(*s, dtype=torch.bfloat16) * 0.1)(D, 3 * D)),
            "wo": _w((lambda *s: torch.randn(*s, dtype=torch.bfloat16) * 0.05)(D, D)),
        }
    _A_in = _A_setup()

    def _B_setup():
        B, S, D, F, C = 1, 2048, 640, 1728, 8
        return {
            "x": _w((lambda *s: torch.randn(*s, dtype=torch.bfloat16) * 0.05)(B, S, D)),
            "w_r": _w((lambda *s: torch.randn(*s, dtype=torch.bfloat16) * 1.6)(D)),
            "w_gate": _w((lambda *s: torch.randn(*s, dtype=torch.bfloat16) * 0.1)(D, F)),
            "w_up": _w((lambda *s: torch.randn(*s, dtype=torch.bfloat16) * 0.1)(D, F)),
            "w_down": _w((lambda *s: torch.randn(*s, dtype=torch.bfloat16) * 0.1)(F, D)),
        }
    _B_in = _B_setup()

    return {
        "A_x": _A_in["x"],
        "A_wqkv": _A_in["wqkv"],
        "A_wo": _A_in["wo"],
        "B_x": _B_in["x"],
        "B_w_r": _B_in["w_r"],
        "B_w_gate": _B_in["w_gate"],
        "B_w_up": _B_in["w_up"],
        "B_w_down": _B_in["w_down"],
    }

def reference(A_x, A_wqkv, A_wo, B_x, B_w_r, B_w_gate, B_w_up, B_w_down):
    def _A_ref(x, wqkv, wo):
        B, S, D = x.shape
        H = 32; Dh = D // H
        qkv = (lambda x, *d: x.permute(*d))((x @ wqkv).reshape(B, S, 3, H, Dh), 2, 0, 3, 1, 4)
        q, k, v = qkv[0], qkv[1], qkv[2]
        scale = Dh ** -0.5
        scores = torch.einsum("bhqd,bhkd->bhqk", q, k) * scale
        p = _softmax(scores, axis=-1)
        o = torch.einsum("bhqk,bhkd->bhqd", p, v)
        return (lambda x, *d: x.permute(*d))(o, 0, 2, 1, 3).reshape(B, S, D) @ wo

    def _B_ref(x, w_r, w_gate, w_up, w_down):
        B, S, D = x.shape
        C = 8
        r = x @ w_r
        idx = torch.argsort(-r, axis=-1)[:, :C]
        idx_e = (lambda x, n, axis: torch.repeat_interleave(x, n, dim=axis))(idx.reshape(B, C, 1), D, axis=2)
        x_sel = (lambda x, i, axis: torch.take_along_dim(x, i, dim=axis))(x, idx_e, axis=1)
        g = _silu(x_sel @ w_gate)
        u = x_sel @ w_up
        y = (g * u) @ w_down
        r_sel = _sigmoid((lambda x, i, axis: torch.take_along_dim(x, i, dim=axis))(r, idx, axis=1))
        y = y * r_sel.reshape(B, C, 1)
        b_off = (torch.arange(B) * S).reshape(B, 1)
        flat_idx = (idx + b_off).reshape(B * C)
        zero = (x * 0.0).reshape(B * S, D)
        upd = _scatter_add(zero, flat_idx, y.reshape(B * C, D), axis=0)
        return x + upd.reshape(B, S, D)

    x = A_x
    xn = _layernorm(x, axis=-1)
    return x + _A_ref(xn, A_wqkv, A_wo) + _B_ref(xn, B_w_r, B_w_gate, B_w_up, B_w_down)
```

```asm
; @launch grid=(256,1,1) block=(768,1,1) lds=163840
.amdgcn_target "amdgcn-amd-amdhsa--gfx950"
.text
.globl parallel_sum__softmax_full_mha__moe_arch_mod__prompt_kernel
.p2align 8
.type parallel_sum__softmax_full_mha__moe_arch_mod__prompt_kernel,@function
parallel_sum__softmax_full_mha__moe_arch_mod__prompt_kernel:
    s_cmp_ge_u32 s2, 256
    s_cbranch_scc1 L_end
    s_load_dwordx4 s[4:7], s[0:1], 0
    s_load_dwordx2 s[8:9], s[0:1], 80
    s_load_dwordx2 s[10:11], s[0:1], 32
    s_load_dwordx2 s[12:13], s[0:1], 72
    s_load_dwordx2 s[14:15], s[0:1], 16
    s_load_dwordx2 s[16:17], s[0:1], 64
    s_load_dwordx4 s[20:23], s[0:1], 40
    s_load_dwordx2 s[18:19], s[0:1], 56
    v_lshrrev_b32 v2, 6, v0
    v_and_b32 v1, 63, v0
    v_readfirstlane_b32 s24, v2
    s_lshr_b32 s3, s2, 3
    s_lshl4_add_u32 s29, s3, s24
    s_and_b32 s29, s29, 0x1cf
    s_cmp_lg_u32 s29, 11
    s_cbranch_scc1 L_nct
    s_mov_b32 s29, s3
    s_getpc_b64 s[70:71]
L_ct_a:
    s_sub_u32 s70, s70, L_ct_a-parallel_sum__softmax_full_mha__moe_arch_mod__prompt_kernel
    s_subb_u32 s71, s71, 0
    s_lshl_b32 s29, s29, 6
    v_add_u32 v2, s29, v1
    v_min_u32 v2, (L_end-parallel_sum__softmax_full_mha__moe_arch_mod__prompt_kernel)/128, v2
    v_lshlrev_b32 v2, 7, v2
    global_load_dword v3, v2, s[70:71]
L_nct:
    s_and_b32 s30, s3, 3
    s_lshr_b32 s29, s3, 2
    s_and_b32 s31, s2, 7
    s_lshl2_add_u32 s27, s31, s30
    s_mov_b32 s28, s29
    s_lshl_b32 s25, s2, 1
    s_and_b32 s25, s25, 12
    s_add_u32 s25, s25, s30
    s_and_b32 s26, s2, 1
    s_lshl3_add_u32 s26, s26, s29
    s_mul_i32 s30, s30, 5
    s_lshr_b32 s30, s30, 1
    s_add_u32 s52, s29, s30
    s_cmp_eq_u32 s24, 8
    s_cbranch_scc1 L1_stat
    s_cmp_gt_u32 s24, 8
    s_cbranch_scc1 L1_idle
    s_cmp_eq_u32 s26, 15
    s_cbranch_scc1 L1_spare
    s_cmp_lt_u32 s24, 4
    s_cbranch_scc1 L1_cons
    s_setprio 1
    s_sub_u32 s29, s52, 10
    s_cmp_ge_u32 s52, 10
    s_cselect_b32 s52, s29, s52
    s_sub_u32 s29, s24, 4
    s_lshl_b32 s53, s29, 12
    s_lshl2_add_u32 s30, s25, s29
    s_mul_i32 s30, s30, 40960
    v_lshrrev_b32 v2, 3, v1
    v_mul_u32_u24 v2, 1280, v2
    v_lshrrev_b32 v3, 4, v1
    v_and_b32 v12, 7, v1
    v_xor_b32 v12, v12, v3
    v_lshlrev_b32 v12, 4, v12
    v_add3_u32 v4, v2, v12, s30
    v_xor_b32 v5, 64, v4
    v_add_u32 v5, 9216, v5
    v_add_u32 v6, 18432, v4
    v_add_u32 v7, 18432, v5
    s_mul_i32 s30, s29, 61440
    s_lshl_b32 s31, s26, 8
    s_add_u32 s30, s30, s31
    v_mul_u32_u24 v2, 3840, v3
    v_lshlrev_b32 v3, 2, v3
    v_and_b32 v12, 15, v1
    v_xor_b32 v12, v12, v3
    v_lshlrev_b32 v12, 4, v12
    v_add3_u32 v8, v2, v12, s30
    v_add_u32 v9, 14336, v8
    v_add_u32 v10, 28672, v8
    v_add_u32 v11, 43008, v8
    s_waitcnt lgkmcnt(0)
    s_mov_b32 s32, s4
    s_mov_b32 s33, s5
    s_mov_b32 s34, 2621440
    s_mov_b32 s35, 0x20000
    s_mov_b32 s36, s6
    s_mov_b32 s37, s7
    s_mov_b32 s38, 2457600
    s_mov_b32 s39, 0x20000
    s_mov_b32 s57, 10
L1_ld_loop:
    s_lshl_b32 s55, s52, 7
    s_mul_i32 s56, s52, 245760
    s_mov_b32 m0, s53
    s_add_u32 s54, s53, 16384
    buffer_load_dwordx4 v4, s[32:35], s55 offen offset:0 lds
    buffer_load_dwordx4 v5, s[32:35], s55 offen offset:1024 lds
    buffer_load_dwordx4 v6, s[32:35], s55 offen offset:2048 lds
    buffer_load_dwordx4 v7, s[32:35], s55 offen offset:3072 lds
    s_mov_b32 m0, s54
    s_add_u32 s52, s52, 1
    buffer_load_dwordx4 v8, s[36:39], s56 offen offset:0 lds
    buffer_load_dwordx4 v9, s[36:39], s56 offen offset:1024 lds
    buffer_load_dwordx4 v10, s[36:39], s56 offen offset:2048 lds
    buffer_load_dwordx4 v11, s[36:39], s56 offen offset:3072 lds
    s_cmp_eq_u32 s52, 10
    s_cselect_b32 s52, 0, s52
    s_add_u32 s53, s53, 32768
    s_and_b32 s53, s53, 0x1ffff
    s_sub_u32 s57, s57, 1
    s_cmp_gt_u32 s57, 8
    s_cbranch_scc1 L1_ld_loop
    s_waitcnt vmcnt(8)
    s_barrier
    s_cmp_lg_u32 s57, 0
    s_cbranch_scc1 L1_ld_loop
    s_waitcnt vmcnt(0)
    s_barrier
    s_mov_b32 s40, s8
    s_mov_b32 s41, s9
    s_mov_b32 s42, 13952256
    s_mov_b32 s43, 0x20000
    s_setprio 0
    s_barrier
    s_branch L2_attn
L1_stat:
    s_setprio 3
    s_mov_b32 s68, 0x3f803f80
    s_lshl4_add_u32 s29, s25, s26
    s_lshl_b32 s29, s29, 3
    v_lshrrev_b32 v2, 4, v1
    v_add_u32 v2, s29, v2
    v_mul_u32_u24 v3, 1280, v2
    v_and_b32 v4, 15, v1
    v_lshlrev_b32 v4, 4, v4
    v_add_u32 v3, v3, v4
    s_mov_b32 s30, 5120
    s_waitcnt lgkmcnt(0)
    s_mov_b32 s32, s4
    s_mov_b32 s33, s5
    s_mov_b32 s34, 2621440
    s_mov_b32 s35, 0x20000
    s_mov_b32 s36, s10
    s_mov_b32 s37, s11
    s_mov_b32 s38, 1280
    s_mov_b32 s39, 0x20000
    buffer_load_dwordx4 v[64:67], v4, s[36:39], 0 offen offset:0
    buffer_load_dwordx4 v[68:71], v4, s[36:39], 0 offen offset:256
    buffer_load_dwordx4 v[72:75], v4, s[36:39], 0 offen offset:512
    buffer_load_dwordx4 v[76:79], v4, s[36:39], 0 offen offset:768
    buffer_load_dwordx4 v[80:83], v4, s[36:39], 0 offen offset:1024
    buffer_load_dwordx4 v[24:27], v3, s[32:35], 0 offen offset:0
    buffer_load_dwordx4 v[28:31], v3, s[32:35], 0 offen offset:256
    buffer_load_dwordx4 v[32:35], v3, s[32:35], 0 offen offset:512
    buffer_load_dwordx4 v[36:39], v3, s[32:35], 0 offen offset:768
    buffer_load_dwordx4 v[40:43], v3, s[32:35], 0 offen offset:1024
    buffer_load_dwordx4 v[44:47], v3, s[32:35], s30 offen offset:0
    buffer_load_dwordx4 v[48:51], v3, s[32:35], s30 offen offset:256
    buffer_load_dwordx4 v[52:55], v3, s[32:35], s30 offen offset:512
    buffer_load_dwordx4 v[56:59], v3, s[32:35], s30 offen offset:768
    buffer_load_dwordx4 v[60:63], v3, s[32:35], s30 offen offset:1024
    s_mov_b32 s40, s8
    s_mov_b32 s41, s9
    s_mov_b32 s42, 13952256
    s_mov_b32 s43, 0x20000
    v_mov_b32 v16, 0
    v_mov_b32 v17, 0
    v_mov_b32 v18, 0
    v_mov_b32 v19, 0
    v_mov_b32 v20, 0
    v_mov_b32 v21, 0
    v_mov_b32 v22, 0
    s_waitcnt vmcnt(10)
    v_dot2c_f32_bf16 v22, s68, v64
    v_dot2c_f32_bf16 v22, s68, v65
    v_dot2c_f32_bf16 v22, s68, v66
    v_dot2c_f32_bf16 v22, s68, v67
    v_dot2c_f32_bf16 v22, s68, v68
    v_dot2c_f32_bf16 v22, s68, v69
    v_dot2c_f32_bf16 v22, s68, v70
    v_dot2c_f32_bf16 v22, s68, v71
    v_dot2c_f32_bf16 v22, s68, v72
    v_dot2c_f32_bf16 v22, s68, v73
    v_dot2c_f32_bf16 v22, s68, v74
    v_dot2c_f32_bf16 v22, s68, v75
    v_dot2c_f32_bf16 v22, s68, v76
    v_dot2c_f32_bf16 v22, s68, v77
    v_dot2c_f32_bf16 v22, s68, v78
    v_dot2c_f32_bf16 v22, s68, v79
    v_dot2c_f32_bf16 v22, s68, v80
    v_dot2c_f32_bf16 v22, s68, v81
    v_dot2c_f32_bf16 v22, s68, v82
    v_dot2c_f32_bf16 v22, s68, v83
    s_waitcnt vmcnt(9)
    v_dot2c_f32_bf16 v16, s68, v24
    v_dot2c_f32_bf16 v18, v24, v24
    v_dot2c_f32_bf16 v20, v64, v24
    v_dot2c_f32_bf16 v16, s68, v25
    v_dot2c_f32_bf16 v18, v25, v25
    v_dot2c_f32_bf16 v20, v65, v25
    v_dot2c_f32_bf16 v16, s68, v26
    v_dot2c_f32_bf16 v18, v26, v26
    v_dot2c_f32_bf16 v20, v66, v26
    v_dot2c_f32_bf16 v16, s68, v27
    v_dot2c_f32_bf16 v18, v27, v27
    v_dot2c_f32_bf16 v20, v67, v27
    s_waitcnt vmcnt(8)
    v_dot2c_f32_bf16 v16, s68, v28
    v_dot2c_f32_bf16 v18, v28, v28
    v_dot2c_f32_bf16 v20, v68, v28
    v_dot2c_f32_bf16 v16, s68, v29
    v_dot2c_f32_bf16 v18, v29, v29
    v_dot2c_f32_bf16 v20, v69, v29
    v_dot2c_f32_bf16 v16, s68, v30
    v_dot2c_f32_bf16 v18, v30, v30
    v_dot2c_f32_bf16 v20, v70, v30
    v_dot2c_f32_bf16 v16, s68, v31
    v_dot2c_f32_bf16 v18, v31, v31
    v_dot2c_f32_bf16 v20, v71, v31
    s_waitcnt vmcnt(7)
    v_dot2c_f32_bf16 v16, s68, v32
    v_dot2c_f32_bf16 v18, v32, v32
    v_dot2c_f32_bf16 v20, v72, v32
    v_dot2c_f32_bf16 v16, s68, v33
    v_dot2c_f32_bf16 v18, v33, v33
    v_dot2c_f32_bf16 v20, v73, v33
    v_dot2c_f32_bf16 v16, s68, v34
    v_dot2c_f32_bf16 v18, v34, v34
    v_dot2c_f32_bf16 v20, v74, v34
    v_dot2c_f32_bf16 v16, s68, v35
    v_dot2c_f32_bf16 v18, v35, v35
    v_dot2c_f32_bf16 v20, v75, v35
    s_waitcnt vmcnt(6)
    v_dot2c_f32_bf16 v16, s68, v36
    v_dot2c_f32_bf16 v18, v36, v36
    v_dot2c_f32_bf16 v20, v76, v36
    v_dot2c_f32_bf16 v16, s68, v37
    v_dot2c_f32_bf16 v18, v37, v37
    v_dot2c_f32_bf16 v20, v77, v37
    v_dot2c_f32_bf16 v16, s68, v38
    v_dot2c_f32_bf16 v18, v38, v38
    v_dot2c_f32_bf16 v20, v78, v38
    v_dot2c_f32_bf16 v16, s68, v39
    v_dot2c_f32_bf16 v18, v39, v39
    v_dot2c_f32_bf16 v20, v79, v39
    s_waitcnt vmcnt(5)
    v_dot2c_f32_bf16 v16, s68, v40
    v_dot2c_f32_bf16 v18, v40, v40
    v_dot2c_f32_bf16 v20, v80, v40
    v_dot2c_f32_bf16 v16, s68, v41
    v_dot2c_f32_bf16 v18, v41, v41
    v_dot2c_f32_bf16 v20, v81, v41
    v_dot2c_f32_bf16 v16, s68, v42
    v_dot2c_f32_bf16 v18, v42, v42
    v_dot2c_f32_bf16 v20, v82, v42
    v_dot2c_f32_bf16 v16, s68, v43
    v_dot2c_f32_bf16 v18, v43, v43
    v_dot2c_f32_bf16 v20, v83, v43
    s_waitcnt vmcnt(4)
    v_dot2c_f32_bf16 v17, s68, v44
    v_dot2c_f32_bf16 v19, v44, v44
    v_dot2c_f32_bf16 v21, v64, v44
    v_dot2c_f32_bf16 v17, s68, v45
    v_dot2c_f32_bf16 v19, v45, v45
    v_dot2c_f32_bf16 v21, v65, v45
    v_dot2c_f32_bf16 v17, s68, v46
    v_dot2c_f32_bf16 v19, v46, v46
    v_dot2c_f32_bf16 v21, v66, v46
    v_dot2c_f32_bf16 v17, s68, v47
    v_dot2c_f32_bf16 v19, v47, v47
    v_dot2c_f32_bf16 v21, v67, v47
    s_waitcnt vmcnt(3)
    v_dot2c_f32_bf16 v17, s68, v48
    v_dot2c_f32_bf16 v19, v48, v48
    v_dot2c_f32_bf16 v21, v68, v48
    v_dot2c_f32_bf16 v17, s68, v49
    v_dot2c_f32_bf16 v19, v49, v49
    v_dot2c_f32_bf16 v21, v69, v49
    v_dot2c_f32_bf16 v17, s68, v50
    v_dot2c_f32_bf16 v19, v50, v50
    v_dot2c_f32_bf16 v21, v70, v50
    v_dot2c_f32_bf16 v17, s68, v51
    v_dot2c_f32_bf16 v19, v51, v51
    v_dot2c_f32_bf16 v21, v71, v51
    s_waitcnt vmcnt(2)
    v_dot2c_f32_bf16 v17, s68, v52
    v_dot2c_f32_bf16 v19, v52, v52
    v_dot2c_f32_bf16 v21, v72, v52
    v_dot2c_f32_bf16 v17, s68, v53
    v_dot2c_f32_bf16 v19, v53, v53
    v_dot2c_f32_bf16 v21, v73, v53
    v_dot2c_f32_bf16 v17, s68, v54
    v_dot2c_f32_bf16 v19, v54, v54
    v_dot2c_f32_bf16 v21, v74, v54
    v_dot2c_f32_bf16 v17, s68, v55
    v_dot2c_f32_bf16 v19, v55, v55
    v_dot2c_f32_bf16 v21, v75, v55
    s_waitcnt vmcnt(1)
    v_dot2c_f32_bf16 v17, s68, v56
    v_dot2c_f32_bf16 v19, v56, v56
    v_dot2c_f32_bf16 v21, v76, v56
    v_dot2c_f32_bf16 v17, s68, v57
    v_dot2c_f32_bf16 v19, v57, v57
    v_dot2c_f32_bf16 v21, v77, v57
    v_dot2c_f32_bf16 v17, s68, v58
    v_dot2c_f32_bf16 v19, v58, v58
    v_dot2c_f32_bf16 v21, v78, v58
    v_dot2c_f32_bf16 v17, s68, v59
    v_dot2c_f32_bf16 v19, v59, v59
    v_dot2c_f32_bf16 v21, v79, v59
    s_waitcnt vmcnt(0)
    v_dot2c_f32_bf16 v17, s68, v60
    v_dot2c_f32_bf16 v19, v60, v60
    v_dot2c_f32_bf16 v21, v80, v60
    v_dot2c_f32_bf16 v17, s68, v61
    v_dot2c_f32_bf16 v19, v61, v61
    v_dot2c_f32_bf16 v21, v81, v61
    v_dot2c_f32_bf16 v17, s68, v62
    v_dot2c_f32_bf16 v19, v62, v62
    v_dot2c_f32_bf16 v21, v82, v62
    v_dot2c_f32_bf16 v17, s68, v63
    v_dot2c_f32_bf16 v19, v63, v63
    v_dot2c_f32_bf16 v21, v83, v63
    v_mov_b32 v8, 0
    global_load_dword v9, v8, s[12:13] sc1
    v_and_b32 v5, 1, v1
    v_cmp_eq_u32 vcc, 1, v5
    v_lshl_add_u32 v2, v5, 2, v2
    v_add_f32_dpp v16, v16, v16 row_ror:8 row_mask:0xf bank_mask:0xf
    v_add_f32_dpp v17, v17, v17 row_ror:8 row_mask:0xf bank_mask:0xf
    v_add_f32_dpp v18, v18, v18 row_ror:8 row_mask:0xf bank_mask:0xf
    v_add_f32_dpp v19, v19, v19 row_ror:8 row_mask:0xf bank_mask:0xf
    v_add_f32_dpp v20, v20, v20 row_ror:8 row_mask:0xf bank_mask:0xf
    v_add_f32_dpp v21, v21, v21 row_ror:8 row_mask:0xf bank_mask:0xf
    v_add_f32_dpp v22, v22, v22 row_ror:8 row_mask:0xf bank_mask:0xf
    v_add_f32_dpp v16, v16, v16 row_ror:4 row_mask:0xf bank_mask:0xf
    v_add_f32_dpp v17, v17, v17 row_ror:4 row_mask:0xf bank_mask:0xf
    v_add_f32_dpp v18, v18, v18 row_ror:4 row_mask:0xf bank_mask:0xf
    v_add_f32_dpp v19, v19, v19 row_ror:4 row_mask:0xf bank_mask:0xf
    v_add_f32_dpp v20, v20, v20 row_ror:4 row_mask:0xf bank_mask:0xf
    v_add_f32_dpp v21, v21, v21 row_ror:4 row_mask:0xf bank_mask:0xf
    v_add_f32_dpp v22, v22, v22 row_ror:4 row_mask:0xf bank_mask:0xf
    v_add_f32_dpp v16, v16, v16 row_ror:2 row_mask:0xf bank_mask:0xf
    v_add_f32_dpp v17, v17, v17 row_ror:2 row_mask:0xf bank_mask:0xf
    v_add_f32_dpp v18, v18, v18 row_ror:2 row_mask:0xf bank_mask:0xf
    v_add_f32_dpp v19, v19, v19 row_ror:2 row_mask:0xf bank_mask:0xf
    v_add_f32_dpp v20, v20, v20 row_ror:2 row_mask:0xf bank_mask:0xf
    v_add_f32_dpp v21, v21, v21 row_ror:2 row_mask:0xf bank_mask:0xf
    v_add_f32_dpp v22, v22, v22 row_ror:2 row_mask:0xf bank_mask:0xf
    v_add_f32_dpp v16, v16, v16 row_ror:1 row_mask:0xf bank_mask:0xf
    v_add_f32_dpp v17, v17, v17 row_ror:1 row_mask:0xf bank_mask:0xf
    v_add_f32_dpp v18, v18, v18 row_ror:1 row_mask:0xf bank_mask:0xf
    v_add_f32_dpp v19, v19, v19 row_ror:1 row_mask:0xf bank_mask:0xf
    v_add_f32_dpp v20, v20, v20 row_ror:1 row_mask:0xf bank_mask:0xf
    v_add_f32_dpp v21, v21, v21 row_ror:1 row_mask:0xf bank_mask:0xf
    v_add_f32_dpp v22, v22, v22 row_ror:1 row_mask:0xf bank_mask:0xf
    v_cndmask_b32 v16, v16, v17, vcc
    v_cndmask_b32 v18, v18, v19, vcc
    v_cndmask_b32 v20, v20, v21, vcc
    v_mul_f32 v5, 0x3acccccd, v16
    v_mul_f32 v6, 0x3acccccd, v18
    v_fma_f32 v6, -v5, v5, v6
    v_max_f32 v6, 0, v6
    v_cvt_pk_bf16_f32 v12, v5, v5
    v_and_b32 v12, 0xffff0000, v12
    v_cvt_pk_bf16_f32 v6, v6, v6
    v_and_b32 v6, 0xffff0000, v6
    v_add_f32 v6, 0x3727c5ac, v6
    v_cvt_pk_bf16_f32 v6, v6, v6
    v_and_b32 v6, 0xffff0000, v6
    v_sqrt_f32 v6, v6
    s_nop 0
    v_cvt_pk_bf16_f32 v6, v6, v6
    v_and_b32 v6, 0xffff0000, v6
    v_rcp_f32 v13, v6
    s_nop 0
    v_fma_f32 v20, -v12, v22, v20
    v_mul_f32 v14, v13, v20
    v_ashrrev_i32 v5, 31, v14
    v_or_b32 v5, 0x80000000, v5
    v_xor_b32 v5, v5, v14
    v_and_b32 v5, 0xfffff800, v5
    v_sub_u32 v6, 2047, v2
    v_or_b32 v15, v5, v6
    v_lshlrev_b32 v5, 4, v2
    s_mov_b32 s30, 10493952
    s_lshl_b32 s31, s25, 7
    s_add_u32 s31, s31, 10544384
    v_mov_b32 v7, 1
    s_mov_b32 exec_lo, 0x00030003
    s_mov_b32 exec_hi, 0x00030003
    buffer_store_dwordx4 v[12:15], v5, s[40:43], s30 offen sc1
    s_mov_b64 exec, 1
    s_cmp_eq_u32 s26, 15
    s_cbranch_scc1 L1_st_nb1
    s_barrier
L1_st_nb1:
    s_waitcnt vmcnt(0)
    v_cmp_gt_u32 vcc, 3, v9
    s_cbranch_vccz L_polled_init
    s_mov_b32 s69, 1048576
L_poll_init:
    s_sleep 16
    global_load_dword v9, v8, s[12:13] sc1
    s_sub_u32 s69, s69, 1
    s_cbranch_scc1 L_polled_init
    s_waitcnt vmcnt(0)
    v_cmp_gt_u32 vcc, 3, v9
    s_cbranch_vccnz L_poll_init
L_polled_init:
    buffer_atomic_add v7, v8, s[40:43], s31 offen sc1
    s_cmp_eq_u32 s26, 15
    s_cbranch_scc1 L1_st_spare
    s_barrier
    s_barrier
    s_barrier
    s_barrier
    s_barrier
    buffer_load_dword v7, v8, s[40:43], s31 offen sc1
    s_barrier
    s_waitcnt vmcnt(0)
    v_cmp_gt_u32 vcc, 16, v7
    s_cbranch_vccz L_polled_st
    s_mov_b32 s69, 1048576
L_poll_st:
    buffer_load_dword v7, v8, s[40:43], s31 offen sc1
    s_sub_u32 s69, s69, 1
    s_cbranch_scc1 L_polled_st
    s_waitcnt vmcnt(0)
    v_cmp_gt_u32 vcc, 16, v7
    s_cbranch_vccnz L_poll_st
L_polled_st:
    s_mov_b64 exec, -1
    s_lshl_b32 s31, s25, 11
    s_add_u32 s30, s30, s31
    v_lshlrev_b32 v5, 4, v1
    buffer_load_dwordx2 v[24:25], v5, s[40:43], s30 offen sc1
    buffer_load_dwordx2 v[26:27], v5, s[40:43], s30 offen offset:1024 sc1
    v_lshlrev_b32 v5, 2, v1
    v_add_u32 v5, 131072, v5
    s_barrier
    s_barrier
    s_waitcnt vmcnt(0)
    ds_write2st64_b32 v5, v24, v26 offset0:0 offset1:1
    ds_write2st64_b32 v5, v25, v27 offset0:2 offset1:3
    s_barrier
    s_waitcnt lgkmcnt(0)
    s_barrier
    s_setprio 0
    s_call_b64 s[68:69], L_svsetup
    s_branch L2_service
L1_st_spare:
    s_mov_b64 exec, -1
    s_call_b64 s[68:69], L_svsetup
    s_branch L1_idle_sp
L1_idle:
    s_lshl4_add_u32 s29, s25, s26
    s_cmp_lg_u32 s29, 15
    s_waitcnt lgkmcnt(0)
    s_mov_b32 s40, s8
    s_mov_b32 s41, s9
    s_mov_b32 s42, 13952256
    s_mov_b32 s43, 0x20000
    s_cbranch_scc1 L1_idle_su
    s_sub_u32 s29, s24, 9
    s_mul_i32 s29, s29, 7168
    v_lshl_add_u32 v2, v1, 4, s29
    v_mov_b32 v4, 0
    v_mov_b32 v5, 0
    v_mov_b32 v6, 0
    v_mov_b32 v7, 0
    s_add_u32 s32, s8, 10526976
    s_addc_u32 s33, s9, 0
    s_mov_b32 s34, 21504
    s_mov_b32 s35, 0x20000
    s_mov_b32 s30, 0
    buffer_store_dwordx4 v[4:7], v2, s[32:35], s30 offen offset:0 sc1
    buffer_store_dwordx4 v[4:7], v2, s[32:35], s30 offen offset:1024 sc1
    buffer_store_dwordx4 v[4:7], v2, s[32:35], s30 offen offset:2048 sc1
    buffer_store_dwordx4 v[4:7], v2, s[32:35], s30 offen offset:3072 sc1
    s_mov_b32 s30, 4096
    buffer_store_dwordx4 v[4:7], v2, s[32:35], s30 offen offset:0 sc1
    buffer_store_dwordx4 v[4:7], v2, s[32:35], s30 offen offset:1024 sc1
    buffer_store_dwordx4 v[4:7], v2, s[32:35], s30 offen offset:2048 sc1
    s_mov_b64 exec, 1
    v_mov_b32 v3, 1
    s_waitcnt vmcnt(0)
    global_atomic_add v4, v3, s[12:13] sc1
    s_mov_b64 exec, -1
L1_idle_su:
    s_call_b64 s[68:69], L_svsetup
    s_cmp_eq_u32 s26, 15
    s_cbranch_scc1 L1_idle_sp
    s_barrier
    s_barrier
    s_barrier
    s_barrier
    s_barrier
    s_barrier
    s_barrier
    s_barrier
    s_barrier
    s_barrier
    s_barrier
    s_branch L2_service
L1_idle_sp:
    s_cmp_lg_u32 s25, 0
    s_cbranch_scc1 L2_service
    s_barrier
    s_barrier
    s_barrier
    s_barrier
    s_barrier
    s_branch L2_service
L_svsetup:
    s_sub_u32 s52, s24, 8
    s_mov_b32 s44, s8
    s_mov_b32 s45, s9
    s_mov_b32 s46, 5251072
    s_mov_b32 s47, 0x20000
    s_lshl_b32 s58, s52, 1
    s_cmp_ge_u32 s52, 2
    s_cselect_b32 s59, 8, 0
    s_cselect_b32 s57, 7, 3
    s_add_u32 s55, s58, s59
    s_lshl2_add_u32 s57, s52, s57
    s_cmp_ge_u32 s52, 1
    s_cselect_b32 s59, 9, 1
    s_add_u32 s56, s58, s59
    s_min_u32 s56, s56, 14
    s_lshl_b32 s55, s55, 10
    s_lshl_b32 s56, s56, 10
    s_lshl_b32 s57, s57, 10
    s_mul_i32 s60, s27, 5
    s_lshr_b32 s60, s60, 1
    s_lshl_b32 s60, s60, 9
    s_mul_i32 s58, s27, 1280
    s_add_u32 s58, s58, 40960
    s_mov_b32 s59, 82048
    s_lshr_b32 s61, s55, 4
    v_add_u32 v110, s61, v1
    v_mul_u32_u24 v111, 1425, v110
    v_lshrrev_b32 v111, 18, v111
    v_mul_u32_u24 v112, 184, v111
    v_sub_u32 v110, v110, v112
    v_subrev_u32 v112, 96, v110
    v_mul_u32_u24 v113, 745, v112
    v_bfe_u32 v113, v113, 14, 2
    v_mad_i32_i24 v114, v113, -2, v112
    v_mul_u32_u24 v113, 22, v113
    v_sub_u32 v112, v112, v113
    v_cmp_gt_u32 vcc, 20, v112
    v_lshl_add_u32 v114, v114, 4, s58
    v_lshlrev_b32 v112, 4, v112
    v_add_u32 v112, 81600, v112
    v_cndmask_b32 v114, v112, v114, vcc
    v_cmp_gt_u32 vcc, 96, v110
    v_lshl_add_u32 v110, v110, 4, s60
    v_mul_lo_u32 v111, v111, s59
    v_cndmask_b32 v110, v114, v110, vcc
    v_add_u32 v100, v110, v111
    s_lshr_b32 s61, s56, 4
    v_add_u32 v110, s61, v1
    v_mul_u32_u24 v111, 1425, v110
    v_lshrrev_b32 v111, 18, v111
    v_mul_u32_u24 v112, 184, v111
    v_sub_u32 v110, v110, v112
    v_subrev_u32 v112, 96, v110
    v_mul_u32_u24 v113, 745, v112
    v_bfe_u32 v113, v113, 14, 2
    v_mad_i32_i24 v114, v113, -2, v112
    v_mul_u32_u24 v113, 22, v113
    v_sub_u32 v112, v112, v113
    v_cmp_gt_u32 vcc, 20, v112
    v_lshl_add_u32 v114, v114, 4, s58
    v_lshlrev_b32 v112, 4, v112
    v_add_u32 v112, 81600, v112
    v_cndmask_b32 v114, v112, v114, vcc
    v_cmp_gt_u32 vcc, 96, v110
    v_lshl_add_u32 v110, v110, 4, s60
    v_mul_lo_u32 v111, v111, s59
    v_cndmask_b32 v110, v114, v110, vcc
    v_add_u32 v101, v110, v111
    s_lshr_b32 s61, s57, 4
    v_add_u32 v110, s61, v1
    v_mul_u32_u24 v111, 1425, v110
    v_lshrrev_b32 v111, 18, v111
    v_mul_u32_u24 v112, 184, v111
    v_sub_u32 v110, v110, v112
    v_subrev_u32 v112, 96, v110
    v_mul_u32_u24 v113, 745, v112
    v_bfe_u32 v113, v113, 14, 2
    v_mad_i32_i24 v114, v113, -2, v112
    v_mul_u32_u24 v113, 22, v113
    v_sub_u32 v112, v112, v113
    v_cmp_gt_u32 vcc, 20, v112
    v_lshl_add_u32 v114, v114, 4, s58
    v_lshlrev_b32 v112, 4, v112
    v_add_u32 v112, 81600, v112
    v_cndmask_b32 v114, v112, v114, vcc
    v_cmp_gt_u32 vcc, 96, v110
    v_lshl_add_u32 v110, v110, 4, s60
    v_mul_lo_u32 v111, v111, s59
    v_cndmask_b32 v110, v114, v110, vcc
    v_add_u32 v102, v110, v111
    s_lshr_b32 s61, s57, 4
    s_add_u32 s61, s61, 64
    v_add_u32 v110, s61, v1
    v_mul_u32_u24 v111, 1425, v110
    v_lshrrev_b32 v111, 18, v111
    v_mul_u32_u24 v112, 184, v111
    v_sub_u32 v110, v110, v112
    v_subrev_u32 v112, 96, v110
    v_mul_u32_u24 v113, 745, v112
    v_bfe_u32 v113, v113, 14, 2
    v_mad_i32_i24 v114, v113, -2, v112
    v_mul_u32_u24 v113, 22, v113
    v_sub_u32 v112, v112, v113
    v_cmp_gt_u32 vcc, 20, v112
    v_lshl_add_u32 v114, v114, 4, s58
    v_lshlrev_b32 v112, 4, v112
    v_add_u32 v112, 81600, v112
    v_cndmask_b32 v114, v112, v114, vcc
    v_cmp_gt_u32 vcc, 96, v110
    v_lshl_add_u32 v110, v110, 4, s60
    v_mul_lo_u32 v111, v111, s59
    v_cndmask_b32 v110, v114, v110, vcc
    v_add_u32 v103, v110, v111
    v_subrev_u32 v103, 1024, v103
    s_lshr_b32 s61, s57, 4
    s_add_u32 s61, s61, 128
    v_add_u32 v110, s61, v1
    v_mul_u32_u24 v111, 1425, v110
    v_lshrrev_b32 v111, 18, v111
    v_mul_u32_u24 v112, 184, v111
    v_sub_u32 v110, v110, v112
    v_subrev_u32 v112, 96, v110
    v_mul_u32_u24 v113, 745, v112
    v_bfe_u32 v113, v113, 14, 2
    v_mad_i32_i24 v114, v113, -2, v112
    v_mul_u32_u24 v113, 22, v113
    v_sub_u32 v112, v112, v113
    v_cmp_gt_u32 vcc, 20, v112
    v_lshl_add_u32 v114, v114, 4, s58
    v_lshlrev_b32 v112, 4, v112
    v_add_u32 v112, 81600, v112
    v_cndmask_b32 v114, v112, v114, vcc
    v_cmp_gt_u32 vcc, 96, v110
    v_lshl_add_u32 v110, v110, 4, s60
    v_mul_lo_u32 v111, v111, s59
    v_cndmask_b32 v110, v114, v110, vcc
    v_add_u32 v104, v110, v111
    v_subrev_u32 v104, 2048, v104
    s_lshr_b32 s61, s57, 4
    s_add_u32 s61, s61, 192
    v_add_u32 v110, s61, v1
    v_mul_u32_u24 v111, 1425, v110
    v_lshrrev_b32 v111, 18, v111
    v_mul_u32_u24 v112, 184, v111
    v_sub_u32 v110, v110, v112
    v_subrev_u32 v112, 96, v110
    v_mul_u32_u24 v113, 745, v112
    v_bfe_u32 v113, v113, 14, 2
    v_mad_i32_i24 v114, v113, -2, v112
    v_mul_u32_u24 v113, 22, v113
    v_sub_u32 v112, v112, v113
    v_cmp_gt_u32 vcc, 20, v112
    v_lshl_add_u32 v114, v114, 4, s58
    v_lshlrev_b32 v112, 4, v112
    v_add_u32 v112, 81600, v112
    v_cndmask_b32 v114, v112, v114, vcc
    v_cmp_gt_u32 vcc, 96, v110
    v_lshl_add_u32 v110, v110, 4, s60
    v_mul_lo_u32 v111, v111, s59
    v_cndmask_b32 v110, v114, v110, vcc
    v_add_u32 v105, v110, v111
    v_subrev_u32 v105, 3072, v105
    v_lshlrev_b32 v106, 7, v1
    v_mov_b32 v107, 1
    s_and_b32 s53, s27, 7
    s_mov_b32 s54, 0
    s_and_b32 s67, s2, 7
    s_lshl_b32 s67, s67, 7
    s_and_b32 s58, s2, 7
    s_lshl3_add_u32 s58, s52, s58
    s_min_u32 s58, s58, 26
    s_and_b32 s59, s3, 15
    s_mul_i32 s59, s59, 40
    v_add_u32 v110, s59, v1
    v_mul_u32_u24 v111, 3456, v110
    s_lshl_b32 s59, s58, 7
    v_add_u32 v140, s59, v111
    s_mul_i32 s59, s58, 81920
    v_lshl_add_u32 v141, v110, 7, s59
    s_and_b32 s59, s2, 127
    s_lshl2_add_u32 s59, s59, s52
    s_mul_i32 s59, s59, 13
    v_add_u32 v112, s59, v1
    v_min_u32 v112, 6399, v112
    v_lshlrev_b32 v142, 7, v112
    s_lshl2_add_u32 s58, s28, s52
    s_mul_i32 s58, s58, 81920
    s_add_u32 s58, s58, s60
    s_add_u32 s58, s58, 7872512
    v_bfe_u32 v110, v1, 4, 1
    v_and_b32 v111, 15, v1
    v_min_u32 v111, 11, v111
    v_mul_u32_u24 v110, 40960, v110
    v_lshl_add_u32 v110, v111, 7, v110
    v_add_u32 v158, s58, v110
    s_mul_i32 s59, s3, 26
    s_lshr_b32 s59, s59, 8
    s_mul_i32 s58, s59, 10
    s_sub_u32 s64, s3, s58
    s_and_b32 s63, s2, 7
    s_lshl_b32 s63, s63, 8
    s_mul_i32 s58, s59, 96
    s_add_u32 s63, s63, s58
    s_cmp_eq_u32 s59, 2
    s_cselect_b32 s65, 64, 96
    v_lshrrev_b32 v110, 3, v1
    v_mul_u32_u24 v110, 1280, v110
    v_bfe_u32 v111, v1, 4, 1
    v_lshlrev_b32 v111, 2, v111
    v_and_b32 v112, 7, v1
    v_lshlrev_b32 v144, 2, v112
    v_xor_b32 v111, v111, v112
    v_lshl_add_u32 v110, v111, 4, v110
    s_lshl_b32 s58, s64, 7
    v_add_u32 v143, s58, v110
    v_lshrrev_b32 v110, 4, v1
    v_lshlrev_b32 v145, 4, v110
    v_and_b32 v111, 15, v1
    v_mul_u32_u24 v111, 2560, v111
    v_add_u32 v146, v111, v145
    v_mov_b32 v147, 81920
    v_lshrrev_b32 v111, 1, v1
    v_bfe_u32 v112, v111, 2, 1
    v_bfe_u32 v113, v111, 3, 1
    v_and_b32 v111, 0x13, v111
    v_lshl_add_u32 v111, v112, 3, v111
    v_lshl_add_u32 v111, v113, 2, v111
    v_mul_u32_u24 v111, 3456, v111
    v_and_b32 v112, 1, v1
    v_lshl_add_u32 v148, v112, 4, v111
    v_mul_u32_u24 v111, 1280, v110
    v_and_b32 v112, 15, v1
    v_lshlrev_b32 v113, 1, v110
    v_xor_b32 v112, v112, v113
    s_and_b32 s58, s52, 1
    s_lshl_b32 s58, s58, 3
    v_xor_b32 v112, s58, v112
    v_lshl_add_u32 v149, v112, 4, v111
    v_xor_b32 v150, 128, v149
    v_bfe_u32 v111, v1, 2, 2
    v_and_b32 v112, 3, v1
    v_bfe_u32 v113, v1, 4, 1
    v_lshl_add_u32 v113, v113, 2, v111
    v_bfe_u32 v114, v1, 5, 1
    v_lshl_add_u32 v114, v114, 4, v113
    v_lshlrev_b32 v114, 5, v114
    v_lshl_add_u32 v114, v112, 3, v114
    s_mul_i32 s58, s52, 5120
    s_add_u32 s58, s58, 70656
    v_add_u32 v151, s58, v114
    s_lshl_b32 s58, s52, 1
    v_xor_b32 v113, s58, v113
    v_lshlrev_b32 v113, 5, v113
    v_lshl_add_u32 v113, v112, 3, v113
    v_lshl_add_u32 v111, v110, 2, v111
    v_lshl_add_u32 v113, v111, 8, v113
    v_add_u32 v152, 111616, v113
    v_xor_b32 v153, 32, v152
    v_lshlrev_b32 v110, 2, v1
    s_lshl_b32 s58, s52, 11
    s_add_u32 s58, s58, 132096
    v_add_u32 v154, s58, v110
    s_lshl_b32 s58, s52, 8
    s_add_u32 s58, s58, 132096
    v_add_u32 v155, s58, v110
    v_lshlrev_b32 v110, 3, v1
    v_add_u32 v156, 152576, v110
    s_lshl_b32 s58, s52, 1
    v_add_u32 v157, s58, v156
    s_setpc_b64 s[68:69]
L1_spare:
    s_waitcnt lgkmcnt(0)
    s_mov_b32 s40, s8
    s_mov_b32 s41, s9
    s_mov_b32 s42, 13952256
    s_mov_b32 s43, 0x20000
    s_cmp_lg_u32 s24, 7
    s_cbranch_scc1 L1_sp_nc
    v_lshrrev_b32 v6, 3, v1
    s_mov_b32 s30, 82048
    v_mul_lo_u32 v6, v6, s30
    v_and_b32 v7, 7, v1
    v_cmp_eq_u32 vcc, 0, v7
    v_lshl_add_u32 v6, v7, 4, v6
    v_mov_b32 v7, 0x3f803f80
    s_mul_i32 s30, s25, 328192
    s_add_u32 s30, s30, 81920
    v_cndmask_b32 v12, 0, v7, vcc
    v_cndmask_b32 v13, 0, v7, vcc
    v_cndmask_b32 v14, 0, v7, vcc
    v_cndmask_b32 v15, 0, v7, vcc
    s_mov_b32 exec_hi, 0
    buffer_store_dwordx4 v[12:15], v6, s[40:43], s30 offen sc1
    s_mov_b64 exec, -1
L1_sp_nc:
    s_cmp_lg_u32 s25, 0
    s_cbranch_scc1 L2_attn
    s_cmp_lg_u32 s24, 0
    s_cbranch_scc1 L_polled_sp
    v_mov_b32 v20, -1
    v_mov_b32 v21, 0
    ds_write_b64 v21, v[20:21]
    v_lshlrev_b32 v22, 2, v1
    ds_write_b32 v22, v21 offset:16
    ds_write_b32 v22, v21 offset:12288
    v_and_b32 v2, 15, v1
    v_lshlrev_b32 v2, 7, v2
    s_mov_b32 s53, 1048576
L_poll_sp0:
    s_sleep 16
    global_load_dword v4, v21, s[12:13] sc1
    s_sub_u32 s53, s53, 1
    s_cbranch_scc1 L_polled_sp0
    s_waitcnt vmcnt(0)
    v_cmp_gt_u32 vcc, 3, v4
    s_cbranch_vccnz L_poll_sp0
L_polled_sp0:
    s_mov_b32 s30, 10544384
    s_mov_b32 s53, 1048576
L_poll_sp:
    s_sleep 8
    buffer_load_dword v3, v2, s[40:43], s30 offen sc1
    s_sub_u32 s53, s53, 1
    s_cbranch_scc1 L_polled_sp
    s_waitcnt vmcnt(0)
    v_cmp_gt_u32 vcc, 16, v3
    s_cbranch_vccnz L_poll_sp
L_polled_sp:
    s_waitcnt lgkmcnt(0)
    s_barrier
    v_lshlrev_b32 v2, 4, v0
    s_mov_b32 s30, 10493964
    buffer_load_dword v20, v2, s[40:43], s30 offen sc1
    s_add_u32 s30, s30, 8192
    buffer_load_dword v21, v2, s[40:43], s30 offen sc1
    s_add_u32 s30, s30, 8192
    buffer_load_dword v22, v2, s[40:43], s30 offen sc1
    s_add_u32 s30, s30, 8192
    buffer_load_dword v23, v2, s[40:43], s30 offen sc1
    s_waitcnt vmcnt(0)
    v_max3_u32 v3, v20, v21, v22
    v_max_u32 v3, v3, v23
    s_nop 1
    v_max_u32_dpp v3, v3, v3 row_ror:8 row_mask:0xf bank_mask:0xf
    s_nop 1
    v_max_u32_dpp v3, v3, v3 row_ror:4 row_mask:0xf bank_mask:0xf
    s_nop 1
    v_max_u32_dpp v3, v3, v3 row_ror:2 row_mask:0xf bank_mask:0xf
    s_nop 1
    v_max_u32_dpp v3, v3, v3 row_ror:1 row_mask:0xf bank_mask:0xf
    s_nop 0
    v_readlane_b32 s54, v3, 0
    v_readlane_b32 s55, v3, 16
    v_readlane_b32 s56, v3, 32
    v_readlane_b32 s57, v3, 48
    s_max_u32 s54, s54, s55
    s_max_u32 s56, s56, s57
    s_max_u32 s54, s54, s56
    v_mov_b32 v3, s54
    v_mov_b32 v5, 0
    s_mov_b64 exec, 1
    ds_min_u32 v5, v3
    s_mov_b64 exec, -1
    s_waitcnt lgkmcnt(0)
    s_barrier
    ds_read_b32 v3, v5
    v_mov_b32 v6, 1
    s_waitcnt lgkmcnt(0)
    v_cmp_ge_u32 vcc, v20, v3
    s_and_saveexec_b64 s[54:55], vcc
    s_cbranch_execz L1_sp_c0
    ds_add_rtn_u32 v7, v5, v6 offset:4
    s_waitcnt lgkmcnt(0)
    v_lshlrev_b32 v7, 2, v7
    ds_write_b32 v7, v20 offset:16
L1_sp_c0:
    s_mov_b64 exec, s[54:55]
    v_cmp_ge_u32 vcc, v21, v3
    s_and_saveexec_b64 s[54:55], vcc
    s_cbranch_execz L1_sp_c1
    ds_add_rtn_u32 v7, v5, v6 offset:4
    s_waitcnt lgkmcnt(0)
    v_lshlrev_b32 v7, 2, v7
    ds_write_b32 v7, v21 offset:16
L1_sp_c1:
    s_mov_b64 exec, s[54:55]
    v_cmp_ge_u32 vcc, v22, v3
    s_and_saveexec_b64 s[54:55], vcc
    s_cbranch_execz L1_sp_c2
    ds_add_rtn_u32 v7, v5, v6 offset:4
    s_waitcnt lgkmcnt(0)
    v_lshlrev_b32 v7, 2, v7
    ds_write_b32 v7, v22 offset:16
L1_sp_c2:
    s_mov_b64 exec, s[54:55]
    v_cmp_ge_u32 vcc, v23, v3
    s_and_saveexec_b64 s[54:55], vcc
    s_cbranch_execz L1_sp_c3
    ds_add_rtn_u32 v7, v5, v6 offset:4
    s_waitcnt lgkmcnt(0)
    v_lshlrev_b32 v7, 2, v7
    ds_write_b32 v7, v23 offset:16
L1_sp_c3:
    s_mov_b64 exec, s[54:55]
    s_waitcnt lgkmcnt(0)
    s_barrier
    ds_read_b32 v3, v5 offset:4
    v_lshlrev_b32 v2, 2, v1
    ds_read_b32 v4, v2 offset:16
    s_lshl_b32 s31, s24, 5
    v_mov_b32 v7, s31
    ds_read_b128 v[12:15], v7 offset:16
    ds_read_b128 v[16:19], v7 offset:32
    s_mov_b32 s30, 10526720
    v_mov_b32 v6, 0
    s_waitcnt lgkmcnt(0)
    v_readfirstlane_b32 s53, v3
    v_cmp_gt_u32 s[54:55], v12, v4
    v_cmp_gt_u32 s[56:57], v13, v4
    v_cmp_gt_u32 s[58:59], v14, v4
    v_cmp_gt_u32 s[60:61], v15, v4
    v_cmp_gt_u32 s[62:63], v16, v4
    v_cmp_gt_u32 s[64:65], v17, v4
    v_cmp_gt_u32 s[66:67], v18, v4
    v_cmp_gt_u32 s[68:69], v19, v4
    s_cmp_gt_u32 s53, 64
    s_cbranch_scc1 L1_sp_slow
    v_addc_co_u32 v6, vcc, 0, v6, s[54:55]
    v_addc_co_u32 v6, vcc, 0, v6, s[56:57]
    v_addc_co_u32 v6, vcc, 0, v6, s[58:59]
    v_addc_co_u32 v6, vcc, 0, v6, s[60:61]
    v_addc_co_u32 v6, vcc, 0, v6, s[62:63]
    v_addc_co_u32 v6, vcc, 0, v6, s[64:65]
    v_addc_co_u32 v6, vcc, 0, v6, s[66:67]
    v_addc_co_u32 v6, vcc, 0, v6, s[68:69]
    ds_add_u32 v2, v6 offset:12288
    s_waitcnt lgkmcnt(0)
    s_barrier
    ds_read_b32 v6, v2 offset:12288
    s_waitcnt lgkmcnt(0)
    s_barrier
    s_cmp_lg_u32 s24, 0
    s_cbranch_scc1 L2_attn
    v_cmp_gt_u32 vcc, 8, v6
    v_lshlrev_b32 v2, 2, v6
    s_and_b64 exec, exec, vcc
L1_sp_store:
    v_and_b32 v4, 0x7ff, v4
    v_sub_u32 v4, 2047, v4
    buffer_store_dword v4, v2, s[40:43], s30 offen sc1
    s_mov_b64 exec, -1
    s_branch L2_attn
L1_sp_slow:
    s_barrier
    s_mov_b32 m0, 0
L_top8_a:
    v_max3_u32 v3, v20, v21, v22
    v_max_u32 v3, v3, v23
    s_nop 1
    v_max_u32_dpp v3, v3, v3 row_ror:8 row_mask:0xf bank_mask:0xf
    s_nop 1
    v_max_u32_dpp v3, v3, v3 row_ror:4 row_mask:0xf bank_mask:0xf
    s_nop 1
    v_max_u32_dpp v3, v3, v3 row_ror:2 row_mask:0xf bank_mask:0xf
    s_nop 1
    v_max_u32_dpp v3, v3, v3 row_ror:1 row_mask:0xf bank_mask:0xf
    s_nop 0
    v_readlane_b32 s54, v3, 0
    v_readlane_b32 s55, v3, 16
    v_readlane_b32 s56, v3, 32
    v_readlane_b32 s57, v3, 48
    s_max_u32 s54, s54, s55
    s_max_u32 s56, s56, s57
    s_max_u32 s58, s54, s56
    v_cmp_ne_u32 vcc, s58, v20
    v_cmp_ne_u32 s[54:55], s58, v21
    v_writelane_b32 v4, s58, m0
    s_add_u32 m0, m0, 1
    v_cndmask_b32 v20, 0, v20, vcc
    v_cndmask_b32 v21, 0, v21, s[54:55]
    v_cmp_ne_u32 vcc, s58, v22
    v_cmp_ne_u32 s[54:55], s58, v23
    s_nop 1
    v_cndmask_b32 v22, 0, v22, vcc
    v_cndmask_b32 v23, 0, v23, s[54:55]
    s_cmp_lt_u32 m0, 8
    s_cbranch_scc1 L_top8_a
    v_add_u32 v5, s31, v2
    s_mov_b64 exec, 0xff
    ds_write_b32 v5, v4
    s_mov_b64 exec, -1
    s_waitcnt lgkmcnt(0)
    s_barrier
    s_cmp_lg_u32 s24, 0
    s_cbranch_scc1 L2_attn
    ds_read_b32 v20, v2
    s_waitcnt lgkmcnt(0)
    s_mov_b32 m0, 0
L_top8_b:
    s_nop 1
    v_max_u32_dpp v3, v20, v20 row_ror:8 row_mask:0xf bank_mask:0xf
    s_nop 1
    v_max_u32_dpp v3, v3, v3 row_ror:4 row_mask:0xf bank_mask:0xf
    s_nop 1
    v_max_u32_dpp v3, v3, v3 row_ror:2 row_mask:0xf bank_mask:0xf
    s_nop 1
    v_max_u32_dpp v3, v3, v3 row_ror:1 row_mask:0xf bank_mask:0xf
    s_nop 0
    v_readlane_b32 s54, v3, 0
    v_readlane_b32 s55, v3, 16
    v_readlane_b32 s56, v3, 32
    v_readlane_b32 s57, v3, 48
    s_max_u32 s54, s54, s55
    s_max_u32 s56, s56, s57
    s_max_u32 s58, s54, s56
    v_cmp_ne_u32 vcc, s58, v20
    v_writelane_b32 v4, s58, m0
    s_add_u32 m0, m0, 1
    v_cndmask_b32 v20, 0, v20, vcc
    s_cmp_lt_u32 m0, 8
    s_cbranch_scc1 L_top8_b
    s_mov_b64 exec, 0xff
    s_branch L1_sp_store
L1_cons:
    s_lshr_b32 s58, s24, 1
    s_and_b32 s59, s24, 1
    s_lshl_b32 s30, s58, 1
    s_lshl2_add_u32 s56, s25, s30
    v_mov_b32 v64, 0
    v_mov_b32 v65, 0
    v_mov_b32 v66, 0
    v_mov_b32 v67, 0
    v_mov_b32 v68, 0
    v_mov_b32 v69, 0
    v_mov_b32 v70, 0
    v_mov_b32 v71, 0
    v_mov_b32 v72, 0
    v_mov_b32 v73, 0
    v_mov_b32 v74, 0
    v_mov_b32 v75, 0
    v_mov_b32 v76, 0
    v_mov_b32 v77, 0
    v_mov_b32 v78, 0
    v_mov_b32 v79, 0
    v_mov_b32 v80, 0
    v_mov_b32 v81, 0
    v_mov_b32 v82, 0
    v_mov_b32 v83, 0
    v_mov_b32 v84, 0
    v_mov_b32 v85, 0
    v_mov_b32 v86, 0
    v_mov_b32 v87, 0
    v_mov_b32 v88, 0
    v_mov_b32 v89, 0
    v_mov_b32 v90, 0
    v_mov_b32 v91, 0
    v_mov_b32 v92, 0
    v_mov_b32 v93, 0
    v_mov_b32 v94, 0
    v_mov_b32 v95, 0
    v_mov_b32 v96, 0
    v_mov_b32 v97, 0
    v_mov_b32 v98, 0
    v_mov_b32 v99, 0
    v_mov_b32 v100, 0
    v_mov_b32 v101, 0
    v_mov_b32 v102, 0
    v_mov_b32 v103, 0
    v_mov_b32 v104, 0
    v_mov_b32 v105, 0
    v_mov_b32 v106, 0
    v_mov_b32 v107, 0
    v_mov_b32 v108, 0
    v_mov_b32 v109, 0
    v_mov_b32 v110, 0
    v_mov_b32 v111, 0
    v_mov_b32 v112, 0
    v_mov_b32 v113, 0
    v_mov_b32 v114, 0
    v_mov_b32 v115, 0
    v_mov_b32 v116, 0
    v_mov_b32 v117, 0
    v_mov_b32 v118, 0
    v_mov_b32 v119, 0
    v_mov_b32 v120, 0
    v_mov_b32 v121, 0
    v_mov_b32 v122, 0
    v_mov_b32 v123, 0
    v_mov_b32 v124, 0
    v_mov_b32 v125, 0
    v_mov_b32 v126, 0
    v_mov_b32 v127, 0
    v_lshrrev_b32 v2, 5, v1
    v_mov_b32 v28, 0
    v_mov_b32 v29, 0
    v_mov_b32 v30, 0
    v_mov_b32 v31, 0
    v_lshrrev_b32 v3, 4, v1
    v_xor_b32 v3, v3, v1
    v_and_b32 v3, 1, v3
    v_cmp_eq_u32 vcc, 0, v3
    v_mov_b32 v4, 0x3f803f80
    s_nop 0
    v_cndmask_b32 v24, 0, v4, vcc
    v_cndmask_b32 v25, 0, v4, vcc
    v_cndmask_b32 v26, 0, v4, vcc
    v_cndmask_b32 v27, 0, v4, vcc
    v_bfe_u32 v3, v1, 2, 2
    v_bfe_u32 v4, v1, 4, 1
    v_bfe_u32 v5, v1, 1, 1
    v_lshl_add_u32 v4, v4, 1, v5
    s_lshl1_add_u32 s29, s59, s58
    v_xor_b32 v5, s29, v3
    v_lshl_add_u32 v4, v5, 2, v4
    v_lshl_add_u32 v5, v2, 3, v3
    v_lshlrev_b32 v5, 8, v5
    v_lshl_add_u32 v5, v4, 4, v5
    v_and_b32 v4, 1, v1
    v_lshl_add_u32 v5, v4, 3, v5
    v_add_u32 v13, 16384, v5
    v_xor_b32 v14, 64, v13
    v_and_b32 v8, 31, v1
    s_waitcnt lgkmcnt(0)
    s_mov_b32 s40, s8
    s_mov_b32 s41, s9
    s_mov_b32 s42, 13952256
    s_mov_b32 s43, 0x20000
    s_cmp_ge_u32 s26, 10
    s_cbranch_scc1 L1_consV
    s_lshl_b32 s30, s58, 13
    v_lshl_add_u32 v3, v8, 7, s30
    v_bfe_u32 v4, v8, 1, 3
    v_xor_b32 v4, v4, v2
    v_lshl_add_u32 v9, v4, 4, v3
    v_xor_b32 v10, 32, v9
    v_xor_b32 v11, 64, v9
    v_xor_b32 v12, 96, v9
    s_mov_b32 s60, 82048
    s_cmp_lt_u32 s26, 5
    s_cmov_b32 s60, 40960
    s_cselect_b32 s61, 5251072, 0
    s_cselect_b32 s55, 0x3ea52b5c, 1.0
    s_cselect_b32 s30, 0, 5
    s_sub_u32 s30, s26, s30
    s_lshl2_add_u32 s30, s30, s29
    s_lshl_b32 s30, s30, 11
    v_lshl_add_u32 v21, v1, 4, s30
    v_xor_b32 v22, 0x800, v21
    s_mul_i32 s56, s56, s60
    s_add_u32 s56, s56, s61
    s_add_u32 s57, s56, s60
    s_mov_b32 s53, 0
    s_mov_b32 s54, 10
    v_add_u32 v15, s53, v9
    v_add_u32 v16, s53, v10
    v_add_u32 v17, s53, v11
    v_add_u32 v18, s53, v12
    v_add_u32 v19, s53, v13
    v_add_u32 v20, s53, v14
    s_barrier
    ds_read_b128 v[32:35], v15 offset:0
    ds_read_b64_tr_b16 v[48:49], v19 offset:0
    ds_read_b64_tr_b16 v[50:51], v19 offset:1024
    ds_read_b64_tr_b16 v[52:53], v20 offset:0
    ds_read_b64_tr_b16 v[54:55], v20 offset:1024
    ds_read_b128 v[36:39], v15 offset:4096
L1_loopQ:
    s_waitcnt lgkmcnt(3)
    v_mfma_f32_32x32x16_bf16 v[64:79], v[48:51], v[32:35], v[64:79]
    ds_read_b128 v[40:43], v16 offset:0
    ds_read_b64_tr_b16 v[56:57], v19 offset:4096
    s_waitcnt lgkmcnt(3)
    v_mfma_f32_32x32x16_bf16 v[80:95], v[52:55], v[32:35], v[80:95]
    ds_read_b64_tr_b16 v[58:59], v19 offset:5120
    ds_read_b64_tr_b16 v[60:61], v20 offset:4096
    s_waitcnt lgkmcnt(4)
    v_mfma_f32_32x32x16_bf16 v[96:111], v[48:51], v[36:39], v[96:111]
    ds_read_b64_tr_b16 v[62:63], v20 offset:5120
    ds_read_b128 v[44:47], v16 offset:4096
    v_mfma_f32_32x32x16_bf16 v[112:127], v[52:55], v[36:39], v[112:127]
    v_mfma_f32_16x16x32_bf16 v[28:31], v[48:51], v[24:27], v[28:31]
    s_waitcnt lgkmcnt(3)
    v_mfma_f32_32x32x16_bf16 v[64:79], v[56:59], v[40:43], v[64:79]
    ds_read_b128 v[32:35], v17 offset:0
    ds_read_b64_tr_b16 v[48:49], v19 offset:8192
    s_waitcnt lgkmcnt(3)
    v_mfma_f32_32x32x16_bf16 v[80:95], v[60:63], v[40:43], v[80:95]
    ds_read_b64_tr_b16 v[50:51], v19 offset:9216
    ds_read_b64_tr_b16 v[52:53], v20 offset:8192
    s_waitcnt lgkmcnt(4)
    v_mfma_f32_32x32x16_bf16 v[96:111], v[56:59], v[44:47], v[96:111]
    ds_read_b64_tr_b16 v[54:55], v20 offset:9216
    ds_read_b128 v[36:39], v17 offset:4096
    v_mfma_f32_32x32x16_bf16 v[112:127], v[60:63], v[44:47], v[112:127]
    v_mfma_f32_16x16x32_bf16 v[28:31], v[56:59], v[24:27], v[28:31]
    s_waitcnt lgkmcnt(3)
    v_mfma_f32_32x32x16_bf16 v[64:79], v[48:51], v[32:35], v[64:79]
    ds_read_b128 v[40:43], v18 offset:0
    ds_read_b64_tr_b16 v[56:57], v19 offset:12288
    s_waitcnt lgkmcnt(3)
    v_mfma_f32_32x32x16_bf16 v[80:95], v[52:55], v[32:35], v[80:95]
    ds_read_b64_tr_b16 v[58:59], v19 offset:13312
    ds_read_b64_tr_b16 v[60:61], v20 offset:12288
    s_waitcnt lgkmcnt(4)
    v_mfma_f32_32x32x16_bf16 v[96:111], v[48:51], v[36:39], v[96:111]
    ds_read_b64_tr_b16 v[62:63], v20 offset:13312
    ds_read_b128 v[44:47], v18 offset:4096
    v_mfma_f32_32x32x16_bf16 v[112:127], v[52:55], v[36:39], v[112:127]
    s_add_u32 s53, s53, 32768
    s_and_b32 s53, s53, 0x1ffff
    s_sub_u32 s54, s54, 1
    v_add_u32 v15, s53, v9
    v_add_u32 v16, s53, v10
    v_add_u32 v17, s53, v11
    v_add_u32 v18, s53, v12
    v_add_u32 v19, s53, v13
    v_add_u32 v20, s53, v14
    s_cmp_eq_u32 s54, 0
    v_mfma_f32_16x16x32_bf16 v[28:31], v[48:51], v[24:27], v[28:31]
    s_cbranch_scc1 L1_lastQ
    s_waitcnt lgkmcnt(3)
    v_mfma_f32_32x32x16_bf16 v[64:79], v[56:59], v[40:43], v[64:79]
    s_waitcnt lgkmcnt(0)
    s_barrier
    ds_read_b128 v[32:35], v15 offset:0
    ds_read_b64_tr_b16 v[48:49], v19 offset:0
    v_mfma_f32_32x32x16_bf16 v[80:95], v[60:63], v[40:43], v[80:95]
    ds_read_b64_tr_b16 v[50:51], v19 offset:1024
    ds_read_b64_tr_b16 v[52:53], v20 offset:0
    v_mfma_f32_32x32x16_bf16 v[96:111], v[56:59], v[44:47], v[96:111]
    ds_read_b64_tr_b16 v[54:55], v20 offset:1024
    ds_read_b128 v[36:39], v15 offset:4096
    v_mfma_f32_32x32x16_bf16 v[112:127], v[60:63], v[44:47], v[112:127]
    v_mfma_f32_16x16x32_bf16 v[28:31], v[56:59], v[24:27], v[28:31]
    s_branch L1_loopQ
L1_lastQ:
    s_waitcnt lgkmcnt(3)
    v_mfma_f32_16x16x32_bf16 v[28:31], v[56:59], v[24:27], v[28:31]
    v_mfma_f32_32x32x16_bf16 v[64:79], v[56:59], v[40:43], v[64:79]
    s_waitcnt lgkmcnt(0)
    v_mfma_f32_32x32x16_bf16 v[80:95], v[60:63], v[40:43], v[80:95]
    v_mfma_f32_32x32x16_bf16 v[96:111], v[56:59], v[44:47], v[96:111]
    v_mfma_f32_32x32x16_bf16 v[112:127], v[60:63], v[44:47], v[112:127]
    s_lshl1_add_u32 s29, s59, s58
    s_lshl_b32 s29, s29, 7
    s_add_u32 s29, s29, 131072
    v_lshrrev_b32 v3, 4, v1
    v_lshlrev_b32 v3, 4, v3
    v_and_b32 v4, 1, v1
    v_lshl_add_u32 v3, v4, 6, v3
    v_add_u32 v3, s29, v3
    ds_write_b128 v3, v[28:31] offset:1024
    s_waitcnt lgkmcnt(0)
    s_barrier
    s_lshl_b32 s30, s58, 8
    s_add_u32 s30, s30, 131072
    v_lshl_add_u32 v3, v8, 2, s30
    ds_read2_b32 v[24:25], v3 offset0:0 offset1:32
    ds_read2_b32 v[26:27], v3 offset0:128 offset1:160
    v_lshl_add_u32 v4, v2, 4, s29
    v_xor_b32 v5, 128, v4
    ds_read_b128 v[32:35], v4 offset:1024
    ds_read_b128 v[36:39], v4 offset:1056
    ds_read_b128 v[40:43], v4 offset:1088
    ds_read_b128 v[44:47], v4 offset:1120
    ds_read_b128 v[48:51], v5 offset:1024
    ds_read_b128 v[52:55], v5 offset:1056
    ds_read_b128 v[56:59], v5 offset:1088
    ds_read_b128 v[60:63], v5 offset:1120
    s_waitcnt lgkmcnt(8)
    v_mul_f32 v26, s55, v26
    v_mul_f32 v27, s55, v27
    s_waitcnt lgkmcnt(4)
    v_pk_fma_f32 v[64:65], v[24:25], v[32:33], v[64:65] op_sel:[0,0,0] op_sel_hi:[0,1,1] neg_lo:[1,0,0] neg_hi:[1,0,0]
    v_pk_fma_f32 v[66:67], v[24:25], v[34:35], v[66:67] op_sel:[0,0,0] op_sel_hi:[0,1,1] neg_lo:[1,0,0] neg_hi:[1,0,0]
    v_pk_fma_f32 v[68:69], v[24:25], v[36:37], v[68:69] op_sel:[0,0,0] op_sel_hi:[0,1,1] neg_lo:[1,0,0] neg_hi:[1,0,0]
    v_pk_fma_f32 v[70:71], v[24:25], v[38:39], v[70:71] op_sel:[0,0,0] op_sel_hi:[0,1,1] neg_lo:[1,0,0] neg_hi:[1,0,0]
    v_pk_fma_f32 v[72:73], v[24:25], v[40:41], v[72:73] op_sel:[0,0,0] op_sel_hi:[0,1,1] neg_lo:[1,0,0] neg_hi:[1,0,0]
    v_pk_fma_f32 v[74:75], v[24:25], v[42:43], v[74:75] op_sel:[0,0,0] op_sel_hi:[0,1,1] neg_lo:[1,0,0] neg_hi:[1,0,0]
    v_pk_fma_f32 v[76:77], v[24:25], v[44:45], v[76:77] op_sel:[0,0,0] op_sel_hi:[0,1,1] neg_lo:[1,0,0] neg_hi:[1,0,0]
    v_pk_fma_f32 v[78:79], v[24:25], v[46:47], v[78:79] op_sel:[0,0,0] op_sel_hi:[0,1,1] neg_lo:[1,0,0] neg_hi:[1,0,0]
    v_pk_mul_f32 v[64:65], v[26:27], v[64:65] op_sel:[0,0] op_sel_hi:[0,1]
    v_pk_mul_f32 v[66:67], v[26:27], v[66:67] op_sel:[0,0] op_sel_hi:[0,1]
    v_pk_mul_f32 v[68:69], v[26:27], v[68:69] op_sel:[0,0] op_sel_hi:[0,1]
    v_pk_mul_f32 v[70:71], v[26:27], v[70:71] op_sel:[0,0] op_sel_hi:[0,1]
    v_pk_mul_f32 v[72:73], v[26:27], v[72:73] op_sel:[0,0] op_sel_hi:[0,1]
    v_pk_mul_f32 v[74:75], v[26:27], v[74:75] op_sel:[0,0] op_sel_hi:[0,1]
    v_pk_mul_f32 v[76:77], v[26:27], v[76:77] op_sel:[0,0] op_sel_hi:[0,1]
    v_pk_mul_f32 v[78:79], v[26:27], v[78:79] op_sel:[0,0] op_sel_hi:[0,1]
    v_cvt_pk_bf16_f32 v64, v64, v65
    v_cvt_pk_bf16_f32 v65, v66, v67
    v_cvt_pk_bf16_f32 v66, v68, v69
    v_cvt_pk_bf16_f32 v67, v70, v71
    v_cvt_pk_bf16_f32 v68, v72, v73
    v_cvt_pk_bf16_f32 v69, v74, v75
    v_cvt_pk_bf16_f32 v70, v76, v77
    v_cvt_pk_bf16_f32 v71, v78, v79
    s_nop 0
    v_permlane32_swap_b32 v64, v66
    v_permlane32_swap_b32 v65, v67
    v_permlane32_swap_b32 v68, v70
    v_permlane32_swap_b32 v69, v71
    buffer_store_dwordx4 v[64:67], v21, s[40:43], s56 offen offset:0 sc1
    buffer_store_dwordx4 v[68:71], v21, s[40:43], s56 offen offset:1024 sc1
    v_pk_fma_f32 v[96:97], v[24:25], v[32:33], v[96:97] op_sel:[1,0,0] op_sel_hi:[1,1,1] neg_lo:[1,0,0] neg_hi:[1,0,0]
    v_pk_fma_f32 v[98:99], v[24:25], v[34:35], v[98:99] op_sel:[1,0,0] op_sel_hi:[1,1,1] neg_lo:[1,0,0] neg_hi:[1,0,0]
    v_pk_fma_f32 v[100:101], v[24:25], v[36:37], v[100:101] op_sel:[1,0,0] op_sel_hi:[1,1,1] neg_lo:[1,0,0] neg_hi:[1,0,0]
    v_pk_fma_f32 v[102:103], v[24:25], v[38:39], v[102:103] op_sel:[1,0,0] op_sel_hi:[1,1,1] neg_lo:[1,0,0] neg_hi:[1,0,0]
    v_pk_fma_f32 v[104:105], v[24:25], v[40:41], v[104:105] op_sel:[1,0,0] op_sel_hi:[1,1,1] neg_lo:[1,0,0] neg_hi:[1,0,0]
    v_pk_fma_f32 v[106:107], v[24:25], v[42:43], v[106:107] op_sel:[1,0,0] op_sel_hi:[1,1,1] neg_lo:[1,0,0] neg_hi:[1,0,0]
    v_pk_fma_f32 v[108:109], v[24:25], v[44:45], v[108:109] op_sel:[1,0,0] op_sel_hi:[1,1,1] neg_lo:[1,0,0] neg_hi:[1,0,0]
    v_pk_fma_f32 v[110:111], v[24:25], v[46:47], v[110:111] op_sel:[1,0,0] op_sel_hi:[1,1,1] neg_lo:[1,0,0] neg_hi:[1,0,0]
    v_pk_mul_f32 v[96:97], v[26:27], v[96:97] op_sel:[1,0] op_sel_hi:[1,1]
    v_pk_mul_f32 v[98:99], v[26:27], v[98:99] op_sel:[1,0] op_sel_hi:[1,1]
    v_pk_mul_f32 v[100:101], v[26:27], v[100:101] op_sel:[1,0] op_sel_hi:[1,1]
    v_pk_mul_f32 v[102:103], v[26:27], v[102:103] op_sel:[1,0] op_sel_hi:[1,1]
    v_pk_mul_f32 v[104:105], v[26:27], v[104:105] op_sel:[1,0] op_sel_hi:[1,1]
    v_pk_mul_f32 v[106:107], v[26:27], v[106:107] op_sel:[1,0] op_sel_hi:[1,1]
    v_pk_mul_f32 v[108:109], v[26:27], v[108:109] op_sel:[1,0] op_sel_hi:[1,1]
    v_pk_mul_f32 v[110:111], v[26:27], v[110:111] op_sel:[1,0] op_sel_hi:[1,1]
    v_cvt_pk_bf16_f32 v96, v96, v97
    v_cvt_pk_bf16_f32 v97, v98, v99
    v_cvt_pk_bf16_f32 v98, v100, v101
    v_cvt_pk_bf16_f32 v99, v102, v103
    v_cvt_pk_bf16_f32 v100, v104, v105
    v_cvt_pk_bf16_f32 v101, v106, v107
    v_cvt_pk_bf16_f32 v102, v108, v109
    v_cvt_pk_bf16_f32 v103, v110, v111
    s_nop 0
    v_permlane32_swap_b32 v96, v98
    v_permlane32_swap_b32 v97, v99
    v_permlane32_swap_b32 v100, v102
    v_permlane32_swap_b32 v101, v103
    buffer_store_dwordx4 v[96:99], v21, s[40:43], s57 offen offset:0 sc1
    buffer_store_dwordx4 v[100:103], v21, s[40:43], s57 offen offset:1024 sc1
    s_waitcnt lgkmcnt(0)
    v_pk_fma_f32 v[80:81], v[24:25], v[48:49], v[80:81] op_sel:[0,0,0] op_sel_hi:[0,1,1] neg_lo:[1,0,0] neg_hi:[1,0,0]
    v_pk_fma_f32 v[82:83], v[24:25], v[50:51], v[82:83] op_sel:[0,0,0] op_sel_hi:[0,1,1] neg_lo:[1,0,0] neg_hi:[1,0,0]
    v_pk_fma_f32 v[84:85], v[24:25], v[52:53], v[84:85] op_sel:[0,0,0] op_sel_hi:[0,1,1] neg_lo:[1,0,0] neg_hi:[1,0,0]
    v_pk_fma_f32 v[86:87], v[24:25], v[54:55], v[86:87] op_sel:[0,0,0] op_sel_hi:[0,1,1] neg_lo:[1,0,0] neg_hi:[1,0,0]
    v_pk_fma_f32 v[88:89], v[24:25], v[56:57], v[88:89] op_sel:[0,0,0] op_sel_hi:[0,1,1] neg_lo:[1,0,0] neg_hi:[1,0,0]
    v_pk_fma_f32 v[90:91], v[24:25], v[58:59], v[90:91] op_sel:[0,0,0] op_sel_hi:[0,1,1] neg_lo:[1,0,0] neg_hi:[1,0,0]
    v_pk_fma_f32 v[92:93], v[24:25], v[60:61], v[92:93] op_sel:[0,0,0] op_sel_hi:[0,1,1] neg_lo:[1,0,0] neg_hi:[1,0,0]
    v_pk_fma_f32 v[94:95], v[24:25], v[62:63], v[94:95] op_sel:[0,0,0] op_sel_hi:[0,1,1] neg_lo:[1,0,0] neg_hi:[1,0,0]
    v_pk_mul_f32 v[80:81], v[26:27], v[80:81] op_sel:[0,0] op_sel_hi:[0,1]
    v_pk_mul_f32 v[82:83], v[26:27], v[82:83] op_sel:[0,0] op_sel_hi:[0,1]
    v_pk_mul_f32 v[84:85], v[26:27], v[84:85] op_sel:[0,0] op_sel_hi:[0,1]
    v_pk_mul_f32 v[86:87], v[26:27], v[86:87] op_sel:[0,0] op_sel_hi:[0,1]
    v_pk_mul_f32 v[88:89], v[26:27], v[88:89] op_sel:[0,0] op_sel_hi:[0,1]
    v_pk_mul_f32 v[90:91], v[26:27], v[90:91] op_sel:[0,0] op_sel_hi:[0,1]
    v_pk_mul_f32 v[92:93], v[26:27], v[92:93] op_sel:[0,0] op_sel_hi:[0,1]
    v_pk_mul_f32 v[94:95], v[26:27], v[94:95] op_sel:[0,0] op_sel_hi:[0,1]
    v_cvt_pk_bf16_f32 v80, v80, v81
    v_cvt_pk_bf16_f32 v81, v82, v83
    v_cvt_pk_bf16_f32 v82, v84, v85
    v_cvt_pk_bf16_f32 v83, v86, v87
    v_cvt_pk_bf16_f32 v84, v88, v89
    v_cvt_pk_bf16_f32 v85, v90, v91
    v_cvt_pk_bf16_f32 v86, v92, v93
    v_cvt_pk_bf16_f32 v87, v94, v95
    s_nop 0
    v_permlane32_swap_b32 v80, v82
    v_permlane32_swap_b32 v81, v83
    v_permlane32_swap_b32 v84, v86
    v_permlane32_swap_b32 v85, v87
    buffer_store_dwordx4 v[80:83], v22, s[40:43], s56 offen offset:0 sc1
    buffer_store_dwordx4 v[84:87], v22, s[40:43], s56 offen offset:1024 sc1
    v_pk_fma_f32 v[112:113], v[24:25], v[48:49], v[112:113] op_sel:[1,0,0] op_sel_hi:[1,1,1] neg_lo:[1,0,0] neg_hi:[1,0,0]
    v_pk_fma_f32 v[114:115], v[24:25], v[50:51], v[114:115] op_sel:[1,0,0] op_sel_hi:[1,1,1] neg_lo:[1,0,0] neg_hi:[1,0,0]
    v_pk_fma_f32 v[116:117], v[24:25], v[52:53], v[116:117] op_sel:[1,0,0] op_sel_hi:[1,1,1] neg_lo:[1,0,0] neg_hi:[1,0,0]
    v_pk_fma_f32 v[118:119], v[24:25], v[54:55], v[118:119] op_sel:[1,0,0] op_sel_hi:[1,1,1] neg_lo:[1,0,0] neg_hi:[1,0,0]
    v_pk_fma_f32 v[120:121], v[24:25], v[56:57], v[120:121] op_sel:[1,0,0] op_sel_hi:[1,1,1] neg_lo:[1,0,0] neg_hi:[1,0,0]
    v_pk_fma_f32 v[122:123], v[24:25], v[58:59], v[122:123] op_sel:[1,0,0] op_sel_hi:[1,1,1] neg_lo:[1,0,0] neg_hi:[1,0,0]
    v_pk_fma_f32 v[124:125], v[24:25], v[60:61], v[124:125] op_sel:[1,0,0] op_sel_hi:[1,1,1] neg_lo:[1,0,0] neg_hi:[1,0,0]
    v_pk_fma_f32 v[126:127], v[24:25], v[62:63], v[126:127] op_sel:[1,0,0] op_sel_hi:[1,1,1] neg_lo:[1,0,0] neg_hi:[1,0,0]
    v_pk_mul_f32 v[112:113], v[26:27], v[112:113] op_sel:[1,0] op_sel_hi:[1,1]
    v_pk_mul_f32 v[114:115], v[26:27], v[114:115] op_sel:[1,0] op_sel_hi:[1,1]
    v_pk_mul_f32 v[116:117], v[26:27], v[116:117] op_sel:[1,0] op_sel_hi:[1,1]
    v_pk_mul_f32 v[118:119], v[26:27], v[118:119] op_sel:[1,0] op_sel_hi:[1,1]
    v_pk_mul_f32 v[120:121], v[26:27], v[120:121] op_sel:[1,0] op_sel_hi:[1,1]
    v_pk_mul_f32 v[122:123], v[26:27], v[122:123] op_sel:[1,0] op_sel_hi:[1,1]
    v_pk_mul_f32 v[124:125], v[26:27], v[124:125] op_sel:[1,0] op_sel_hi:[1,1]
    v_pk_mul_f32 v[126:127], v[26:27], v[126:127] op_sel:[1,0] op_sel_hi:[1,1]
    v_cvt_pk_bf16_f32 v112, v112, v113
    v_cvt_pk_bf16_f32 v113, v114, v115
    v_cvt_pk_bf16_f32 v114, v116, v117
    v_cvt_pk_bf16_f32 v115, v118, v119
    v_cvt_pk_bf16_f32 v116, v120, v121
    v_cvt_pk_bf16_f32 v117, v122, v123
    v_cvt_pk_bf16_f32 v118, v124, v125
    v_cvt_pk_bf16_f32 v119, v126, v127
    s_nop 0
    v_permlane32_swap_b32 v112, v114
    v_permlane32_swap_b32 v113, v115
    v_permlane32_swap_b32 v116, v118
    v_permlane32_swap_b32 v117, v119
    buffer_store_dwordx4 v[112:115], v22, s[40:43], s57 offen offset:0 sc1
    buffer_store_dwordx4 v[116:119], v22, s[40:43], s57 offen offset:1024 sc1
    s_branch L2_attn
L1_consV:
    v_bfe_u32 v3, v8, 2, 1
    v_bfe_u32 v4, v8, 3, 1
    v_and_b32 v8, 0x13, v8
    v_lshl_add_u32 v8, v3, 3, v8
    v_lshl_add_u32 v8, v4, 2, v8
    s_lshl_b32 s30, s58, 13
    v_lshl_add_u32 v3, v8, 7, s30
    v_bfe_u32 v4, v8, 1, 3
    v_xor_b32 v4, v4, v2
    v_lshl_add_u32 v9, v4, 4, v3
    v_xor_b32 v10, 32, v9
    v_xor_b32 v11, 64, v9
    v_xor_b32 v12, 96, v9
    s_sub_u32 s30, s26, 10
    s_lshl2_add_u32 s30, s30, s29
    s_lshl_b32 s30, s30, 5
    s_mul_i32 s56, s56, 82048
    s_add_u32 s57, s56, 82048
    v_and_b32 v6, 31, v1
    v_mul_u32_u24 v7, 320, v2
    v_add_u32 v7, 40960, v7
    v_add_u32 v3, s30, v6
    v_mul_u32_u24 v4, 3277, v3
    v_lshrrev_b32 v4, 16, v4
    v_mul_u32_u24 v4, 960, v4
    v_lshl_add_u32 v3, v3, 4, v7
    v_add_u32 v21, v3, v4
    s_xor_b32 s30, s30, 32
    v_add_u32 v3, s30, v6
    v_mul_u32_u24 v4, 3277, v3
    v_lshrrev_b32 v4, 16, v4
    v_mul_u32_u24 v4, 960, v4
    v_lshl_add_u32 v3, v3, 4, v7
    v_add_u32 v22, v3, v4
    s_mov_b32 s53, 0
    s_mov_b32 s54, 10
    v_add_u32 v15, s53, v9
    v_add_u32 v16, s53, v10
    v_add_u32 v17, s53, v11
    v_add_u32 v18, s53, v12
    v_add_u32 v19, s53, v13
    v_add_u32 v20, s53, v14
    s_barrier
    ds_read_b128 v[32:35], v15 offset:0
    ds_read_b64_tr_b16 v[48:49], v19 offset:0
    ds_read_b64_tr_b16 v[50:51], v19 offset:1024
    ds_read_b64_tr_b16 v[52:53], v20 offset:0
    ds_read_b64_tr_b16 v[54:55], v20 offset:1024
    ds_read_b128 v[36:39], v15 offset:4096
L1_loopV:
    s_waitcnt lgkmcnt(3)
    v_mfma_f32_32x32x16_bf16 v[64:79], v[32:35], v[48:51], v[64:79]
    ds_read_b128 v[40:43], v16 offset:0
    ds_read_b64_tr_b16 v[56:57], v19 offset:4096
    s_waitcnt lgkmcnt(3)
    v_mfma_f32_32x32x16_bf16 v[80:95], v[32:35], v[52:55], v[80:95]
    ds_read_b64_tr_b16 v[58:59], v19 offset:5120
    ds_read_b64_tr_b16 v[60:61], v20 offset:4096
    s_waitcnt lgkmcnt(4)
    v_mfma_f32_32x32x16_bf16 v[96:111], v[36:39], v[48:51], v[96:111]
    ds_read_b64_tr_b16 v[62:63], v20 offset:5120
    ds_read_b128 v[44:47], v16 offset:4096
    v_mfma_f32_32x32x16_bf16 v[112:127], v[36:39], v[52:55], v[112:127]
    v_mfma_f32_16x16x32_bf16 v[28:31], v[48:51], v[24:27], v[28:31]
    s_waitcnt lgkmcnt(3)
    v_mfma_f32_32x32x16_bf16 v[64:79], v[40:43], v[56:59], v[64:79]
    ds_read_b128 v[32:35], v17 offset:0
    ds_read_b64_tr_b16 v[48:49], v19 offset:8192
    s_waitcnt lgkmcnt(3)
    v_mfma_f32_32x32x16_bf16 v[80:95], v[40:43], v[60:63], v[80:95]
    ds_read_b64_tr_b16 v[50:51], v19 offset:9216
    ds_read_b64_tr_b16 v[52:53], v20 offset:8192
    s_waitcnt lgkmcnt(4)
    v_mfma_f32_32x32x16_bf16 v[96:111], v[44:47], v[56:59], v[96:111]
    ds_read_b64_tr_b16 v[54:55], v20 offset:9216
    ds_read_b128 v[36:39], v17 offset:4096
    v_mfma_f32_32x32x16_bf16 v[112:127], v[44:47], v[60:63], v[112:127]
    v_mfma_f32_16x16x32_bf16 v[28:31], v[56:59], v[24:27], v[28:31]
    s_waitcnt lgkmcnt(3)
    v_mfma_f32_32x32x16_bf16 v[64:79], v[32:35], v[48:51], v[64:79]
    ds_read_b128 v[40:43], v18 offset:0
    ds_read_b64_tr_b16 v[56:57], v19 offset:12288
    s_waitcnt lgkmcnt(3)
    v_mfma_f32_32x32x16_bf16 v[80:95], v[32:35], v[52:55], v[80:95]
    ds_read_b64_tr_b16 v[58:59], v19 offset:13312
    ds_read_b64_tr_b16 v[60:61], v20 offset:12288
    s_waitcnt lgkmcnt(4)
    v_mfma_f32_32x32x16_bf16 v[96:111], v[36:39], v[48:51], v[96:111]
    ds_read_b64_tr_b16 v[62:63], v20 offset:13312
    ds_read_b128 v[44:47], v18 offset:4096
    v_mfma_f32_32x32x16_bf16 v[112:127], v[36:39], v[52:55], v[112:127]
    s_add_u32 s53, s53, 32768
    s_and_b32 s53, s53, 0x1ffff
    s_sub_u32 s54, s54, 1
    v_add_u32 v15, s53, v9
    v_add_u32 v16, s53, v10
    v_add_u32 v17, s53, v11
    v_add_u32 v18, s53, v12
    v_add_u32 v19, s53, v13
    v_add_u32 v20, s53, v14
    s_cmp_eq_u32 s54, 0
    v_mfma_f32_16x16x32_bf16 v[28:31], v[48:51], v[24:27], v[28:31]
    s_cbranch_scc1 L1_lastV
    s_waitcnt lgkmcnt(3)
    v_mfma_f32_32x32x16_bf16 v[64:79], v[40:43], v[56:59], v[64:79]
    s_waitcnt lgkmcnt(0)
    s_barrier
    ds_read_b128 v[32:35], v15 offset:0
    ds_read_b64_tr_b16 v[48:49], v19 offset:0
    v_mfma_f32_32x32x16_bf16 v[80:95], v[40:43], v[60:63], v[80:95]
    ds_read_b64_tr_b16 v[50:51], v19 offset:1024
    ds_read_b64_tr_b16 v[52:53], v20 offset:0
    v_mfma_f32_32x32x16_bf16 v[96:111], v[44:47], v[56:59], v[96:111]
    ds_read_b64_tr_b16 v[54:55], v20 offset:1024
    ds_read_b128 v[36:39], v15 offset:4096
    v_mfma_f32_32x32x16_bf16 v[112:127], v[44:47], v[60:63], v[112:127]
    v_mfma_f32_16x16x32_bf16 v[28:31], v[56:59], v[24:27], v[28:31]
    s_branch L1_loopV
L1_lastV:
    s_waitcnt lgkmcnt(3)
    v_mfma_f32_16x16x32_bf16 v[28:31], v[56:59], v[24:27], v[28:31]
    v_mfma_f32_32x32x16_bf16 v[64:79], v[40:43], v[56:59], v[64:79]
    s_waitcnt lgkmcnt(0)
    v_mfma_f32_32x32x16_bf16 v[80:95], v[40:43], v[60:63], v[80:95]
    v_mfma_f32_32x32x16_bf16 v[96:111], v[44:47], v[56:59], v[96:111]
    v_mfma_f32_32x32x16_bf16 v[112:127], v[44:47], v[60:63], v[112:127]
    s_lshl1_add_u32 s29, s59, s58
    s_lshl_b32 s29, s29, 7
    s_add_u32 s29, s29, 131072
    v_lshrrev_b32 v3, 4, v1
    v_lshlrev_b32 v3, 4, v3
    v_and_b32 v4, 1, v1
    v_lshl_add_u32 v3, v4, 6, v3
    v_add_u32 v3, s29, v3
    ds_write_b128 v3, v[28:31] offset:1024
    s_waitcnt lgkmcnt(0)
    s_barrier
    v_lshl_add_u32 v4, v6, 2, s29
    v_xor_b32 v5, 128, v4
    ds_read_b32 v24, v4 offset:1024
    ds_read_b32 v25, v5 offset:1024
    s_lshl_b32 s30, s58, 8
    s_add_u32 s30, s30, 131072
    v_lshl_add_u32 v3, v2, 5, s30
    ds_read_b128 v[32:35], v3 offset:0
    ds_read_b128 v[48:51], v3 offset:512
    ds_read_b128 v[36:39], v3 offset:16
    ds_read_b128 v[52:55], v3 offset:528
    ds_read_b128 v[40:43], v3 offset:64
    ds_read_b128 v[56:59], v3 offset:576
    ds_read_b128 v[44:47], v3 offset:80
    ds_read_b128 v[60:63], v3 offset:592
    s_waitcnt lgkmcnt(0)
    v_pk_fma_f32 v[64:65], v[24:25], v[32:33], v[64:65] op_sel:[0,0,0] op_sel_hi:[0,1,1] neg_lo:[1,0,0] neg_hi:[1,0,0]
    v_pk_fma_f32 v[66:67], v[24:25], v[34:35], v[66:67] op_sel:[0,0,0] op_sel_hi:[0,1,1] neg_lo:[1,0,0] neg_hi:[1,0,0]
    v_pk_fma_f32 v[68:69], v[24:25], v[36:37], v[68:69] op_sel:[0,0,0] op_sel_hi:[0,1,1] neg_lo:[1,0,0] neg_hi:[1,0,0]
    v_pk_fma_f32 v[70:71], v[24:25], v[38:39], v[70:71] op_sel:[0,0,0] op_sel_hi:[0,1,1] neg_lo:[1,0,0] neg_hi:[1,0,0]
    v_pk_fma_f32 v[72:73], v[24:25], v[40:41], v[72:73] op_sel:[0,0,0] op_sel_hi:[0,1,1] neg_lo:[1,0,0] neg_hi:[1,0,0]
    v_pk_fma_f32 v[74:75], v[24:25], v[42:43], v[74:75] op_sel:[0,0,0] op_sel_hi:[0,1,1] neg_lo:[1,0,0] neg_hi:[1,0,0]
    v_pk_fma_f32 v[76:77], v[24:25], v[44:45], v[76:77] op_sel:[0,0,0] op_sel_hi:[0,1,1] neg_lo:[1,0,0] neg_hi:[1,0,0]
    v_pk_fma_f32 v[78:79], v[24:25], v[46:47], v[78:79] op_sel:[0,0,0] op_sel_hi:[0,1,1] neg_lo:[1,0,0] neg_hi:[1,0,0]
    v_pk_mul_f32 v[64:65], v[48:49], v[64:65]
    v_pk_mul_f32 v[66:67], v[50:51], v[66:67]
    v_pk_mul_f32 v[68:69], v[52:53], v[68:69]
    v_pk_mul_f32 v[70:71], v[54:55], v[70:71]
    v_pk_mul_f32 v[72:73], v[56:57], v[72:73]
    v_pk_mul_f32 v[74:75], v[58:59], v[74:75]
    v_pk_mul_f32 v[76:77], v[60:61], v[76:77]
    v_pk_mul_f32 v[78:79], v[62:63], v[78:79]
    v_cvt_pk_bf16_f32 v64, v64, v65
    v_cvt_pk_bf16_f32 v65, v66, v67
    v_cvt_pk_bf16_f32 v66, v68, v69
    v_cvt_pk_bf16_f32 v67, v70, v71
    v_cvt_pk_bf16_f32 v68, v72, v73
    v_cvt_pk_bf16_f32 v69, v74, v75
    v_cvt_pk_bf16_f32 v70, v76, v77
    v_cvt_pk_bf16_f32 v71, v78, v79
    buffer_store_dwordx4 v[64:67], v21, s[40:43], s56 offen offset:0 sc1
    buffer_store_dwordx4 v[68:71], v21, s[40:43], s56 offen offset:640 sc1
    v_pk_fma_f32 v[80:81], v[24:25], v[32:33], v[80:81] op_sel:[1,0,0] op_sel_hi:[1,1,1] neg_lo:[1,0,0] neg_hi:[1,0,0]
    v_pk_fma_f32 v[82:83], v[24:25], v[34:35], v[82:83] op_sel:[1,0,0] op_sel_hi:[1,1,1] neg_lo:[1,0,0] neg_hi:[1,0,0]
    v_pk_fma_f32 v[84:85], v[24:25], v[36:37], v[84:85] op_sel:[1,0,0] op_sel_hi:[1,1,1] neg_lo:[1,0,0] neg_hi:[1,0,0]
    v_pk_fma_f32 v[86:87], v[24:25], v[38:39], v[86:87] op_sel:[1,0,0] op_sel_hi:[1,1,1] neg_lo:[1,0,0] neg_hi:[1,0,0]
    v_pk_fma_f32 v[88:89], v[24:25], v[40:41], v[88:89] op_sel:[1,0,0] op_sel_hi:[1,1,1] neg_lo:[1,0,0] neg_hi:[1,0,0]
    v_pk_fma_f32 v[90:91], v[24:25], v[42:43], v[90:91] op_sel:[1,0,0] op_sel_hi:[1,1,1] neg_lo:[1,0,0] neg_hi:[1,0,0]
    v_pk_fma_f32 v[92:93], v[24:25], v[44:45], v[92:93] op_sel:[1,0,0] op_sel_hi:[1,1,1] neg_lo:[1,0,0] neg_hi:[1,0,0]
    v_pk_fma_f32 v[94:95], v[24:25], v[46:47], v[94:95] op_sel:[1,0,0] op_sel_hi:[1,1,1] neg_lo:[1,0,0] neg_hi:[1,0,0]
    v_pk_mul_f32 v[80:81], v[48:49], v[80:81]
    v_pk_mul_f32 v[82:83], v[50:51], v[82:83]
    v_pk_mul_f32 v[84:85], v[52:53], v[84:85]
    v_pk_mul_f32 v[86:87], v[54:55], v[86:87]
    v_pk_mul_f32 v[88:89], v[56:57], v[88:89]
    v_pk_mul_f32 v[90:91], v[58:59], v[90:91]
    v_pk_mul_f32 v[92:93], v[60:61], v[92:93]
    v_pk_mul_f32 v[94:95], v[62:63], v[94:95]
    v_cvt_pk_bf16_f32 v80, v80, v81
    v_cvt_pk_bf16_f32 v81, v82, v83
    v_cvt_pk_bf16_f32 v82, v84, v85
    v_cvt_pk_bf16_f32 v83, v86, v87
    v_cvt_pk_bf16_f32 v84, v88, v89
    v_cvt_pk_bf16_f32 v85, v90, v91
    v_cvt_pk_bf16_f32 v86, v92, v93
    v_cvt_pk_bf16_f32 v87, v94, v95
    buffer_store_dwordx4 v[80:83], v22, s[40:43], s56 offen offset:0 sc1
    buffer_store_dwordx4 v[84:87], v22, s[40:43], s56 offen offset:640 sc1
    ds_read_b128 v[32:35], v3 offset:128
    ds_read_b128 v[48:51], v3 offset:640
    ds_read_b128 v[36:39], v3 offset:144
    ds_read_b128 v[52:55], v3 offset:656
    ds_read_b128 v[40:43], v3 offset:192
    ds_read_b128 v[56:59], v3 offset:704
    ds_read_b128 v[44:47], v3 offset:208
    ds_read_b128 v[60:63], v3 offset:720
    s_waitcnt lgkmcnt(0)
    v_pk_fma_f32 v[96:97], v[24:25], v[32:33], v[96:97] op_sel:[0,0,0] op_sel_hi:[0,1,1] neg_lo:[1,0,0] neg_hi:[1,0,0]
    v_pk_fma_f32 v[98:99], v[24:25], v[34:35], v[98:99] op_sel:[0,0,0] op_sel_hi:[0,1,1] neg_lo:[1,0,0] neg_hi:[1,0,0]
    v_pk_fma_f32 v[100:101], v[24:25], v[36:37], v[100:101] op_sel:[0,0,0] op_sel_hi:[0,1,1] neg_lo:[1,0,0] neg_hi:[1,0,0]
    v_pk_fma_f32 v[102:103], v[24:25], v[38:39], v[102:103] op_sel:[0,0,0] op_sel_hi:[0,1,1] neg_lo:[1,0,0] neg_hi:[1,0,0]
    v_pk_fma_f32 v[104:105], v[24:25], v[40:41], v[104:105] op_sel:[0,0,0] op_sel_hi:[0,1,1] neg_lo:[1,0,0] neg_hi:[1,0,0]
    v_pk_fma_f32 v[106:107], v[24:25], v[42:43], v[106:107] op_sel:[0,0,0] op_sel_hi:[0,1,1] neg_lo:[1,0,0] neg_hi:[1,0,0]
    v_pk_fma_f32 v[108:109], v[24:25], v[44:45], v[108:109] op_sel:[0,0,0] op_sel_hi:[0,1,1] neg_lo:[1,0,0] neg_hi:[1,0,0]
    v_pk_fma_f32 v[110:111], v[24:25], v[46:47], v[110:111] op_sel:[0,0,0] op_sel_hi:[0,1,1] neg_lo:[1,0,0] neg_hi:[1,0,0]
    v_pk_mul_f32 v[96:97], v[48:49], v[96:97]
    v_pk_mul_f32 v[98:99], v[50:51], v[98:99]
    v_pk_mul_f32 v[100:101], v[52:53], v[100:101]
    v_pk_mul_f32 v[102:103], v[54:55], v[102:103]
    v_pk_mul_f32 v[104:105], v[56:57], v[104:105]
    v_pk_mul_f32 v[106:107], v[58:59], v[106:107]
    v_pk_mul_f32 v[108:109], v[60:61], v[108:109]
    v_pk_mul_f32 v[110:111], v[62:63], v[110:111]
    v_cvt_pk_bf16_f32 v96, v96, v97
    v_cvt_pk_bf16_f32 v97, v98, v99
    v_cvt_pk_bf16_f32 v98, v100, v101
    v_cvt_pk_bf16_f32 v99, v102, v103
    v_cvt_pk_bf16_f32 v100, v104, v105
    v_cvt_pk_bf16_f32 v101, v106, v107
    v_cvt_pk_bf16_f32 v102, v108, v109
    v_cvt_pk_bf16_f32 v103, v110, v111
    buffer_store_dwordx4 v[96:99], v21, s[40:43], s57 offen offset:0 sc1
    buffer_store_dwordx4 v[100:103], v21, s[40:43], s57 offen offset:640 sc1
    v_pk_fma_f32 v[112:113], v[24:25], v[32:33], v[112:113] op_sel:[1,0,0] op_sel_hi:[1,1,1] neg_lo:[1,0,0] neg_hi:[1,0,0]
    v_pk_fma_f32 v[114:115], v[24:25], v[34:35], v[114:115] op_sel:[1,0,0] op_sel_hi:[1,1,1] neg_lo:[1,0,0] neg_hi:[1,0,0]
    v_pk_fma_f32 v[116:117], v[24:25], v[36:37], v[116:117] op_sel:[1,0,0] op_sel_hi:[1,1,1] neg_lo:[1,0,0] neg_hi:[1,0,0]
    v_pk_fma_f32 v[118:119], v[24:25], v[38:39], v[118:119] op_sel:[1,0,0] op_sel_hi:[1,1,1] neg_lo:[1,0,0] neg_hi:[1,0,0]
    v_pk_fma_f32 v[120:121], v[24:25], v[40:41], v[120:121] op_sel:[1,0,0] op_sel_hi:[1,1,1] neg_lo:[1,0,0] neg_hi:[1,0,0]
    v_pk_fma_f32 v[122:123], v[24:25], v[42:43], v[122:123] op_sel:[1,0,0] op_sel_hi:[1,1,1] neg_lo:[1,0,0] neg_hi:[1,0,0]
    v_pk_fma_f32 v[124:125], v[24:25], v[44:45], v[124:125] op_sel:[1,0,0] op_sel_hi:[1,1,1] neg_lo:[1,0,0] neg_hi:[1,0,0]
    v_pk_fma_f32 v[126:127], v[24:25], v[46:47], v[126:127] op_sel:[1,0,0] op_sel_hi:[1,1,1] neg_lo:[1,0,0] neg_hi:[1,0,0]
    v_pk_mul_f32 v[112:113], v[48:49], v[112:113]
    v_pk_mul_f32 v[114:115], v[50:51], v[114:115]
    v_pk_mul_f32 v[116:117], v[52:53], v[116:117]
    v_pk_mul_f32 v[118:119], v[54:55], v[118:119]
    v_pk_mul_f32 v[120:121], v[56:57], v[120:121]
    v_pk_mul_f32 v[122:123], v[58:59], v[122:123]
    v_pk_mul_f32 v[124:125], v[60:61], v[124:125]
    v_pk_mul_f32 v[126:127], v[62:63], v[126:127]
    v_cvt_pk_bf16_f32 v112, v112, v113
    v_cvt_pk_bf16_f32 v113, v114, v115
    v_cvt_pk_bf16_f32 v114, v116, v117
    v_cvt_pk_bf16_f32 v115, v118, v119
    v_cvt_pk_bf16_f32 v116, v120, v121
    v_cvt_pk_bf16_f32 v117, v122, v123
    v_cvt_pk_bf16_f32 v118, v124, v125
    v_cvt_pk_bf16_f32 v119, v126, v127
    buffer_store_dwordx4 v[112:115], v22, s[40:43], s57 offen offset:0 sc1
    buffer_store_dwordx4 v[116:119], v22, s[40:43], s57 offen offset:640 sc1
L2_attn:
    s_mov_b32 s32, s4
    s_mov_b32 s33, s5
    s_mov_b32 s34, 2621440
    s_mov_b32 s35, 0x20000
    s_mov_b32 s48, s16
    s_mov_b32 s49, s17
    s_mov_b32 s50, 2621440
    s_mov_b32 s51, 0x20000
    s_and_b32 s57, s27, 1
    s_mul_i32 s61, s27, 5
    s_lshr_b32 s61, s61, 1
    s_lshl_b32 s61, s61, 9
    s_and_b32 s29, s24, 3
    s_lshr_b32 s62, s24, 2
    s_lshl1_add_u32 s29, s29, s62
    s_lshl3_add_u32 s58, s28, s29
    s_mul_i32 s29, s58, 40960
    s_add_u32 s29, s29, s61
    s_add_u32 s59, s29, 5251072
    s_mul_i32 s31, s62, 4294885376
    s_add_u32 s31, s31, 40960
    s_add_u32 s31, s31, s59
    s_mul_i32 s62, s62, 11776
    s_mov_b32 s60, 23552
    s_mov_b32 s52, 0
    s_mov_b32 s53, -1
    s_lshl_b32 s29, s57, 9
    v_lshl_add_u32 v9, v1, 4, s29
    s_mul_i32 s29, s57, 4294966280
    s_add_u32 s29, s29, 1024
    v_and_b32 v3, 31, v1
    v_lshl_add_u32 v6, v3, 4, s29
    v_mov_b32 v4, 1856
    v_cndmask_b32 v10, v6, v4, s[52:53]
    s_lshl_b32 s29, s57, 2
    v_add_u32 v4, s29, v3
    v_subrev_u32 v5, 20, v4
    v_min_u32 v4, v4, v5
    v_cmp_gt_u32 vcc, 20, v3
    v_min_u32 v3, 21, v3
    v_lshrrev_b32 v5, 5, v1
    v_cndmask_b32 v3, v3, v4, vcc
    v_mul_u32_u24 v5, 352, v5
    v_lshl_add_u32 v11, v3, 4, v5
    s_add_u32 s29, s62, 1536
    v_add_u32 v11, s29, v11
    v_mov_b32 v12, 0xdddddddd
    s_mul_i32 s29, s24, 3072
    s_xor_b32 s30, s24, 4
    s_mul_i32 s30, s30, 3072
    v_lshl_add_u32 v127, v1, 4, s29
    v_lshl_add_u32 v128, v1, 4, s30
    v_mov_b32 v48, 0
    v_mov_b32 v49, 0
    v_mov_b32 v50, 0
    v_mov_b32 v51, 0
    v_mov_b32 v52, 0
    v_mov_b32 v53, 0
    v_mov_b32 v54, 0
    v_mov_b32 v55, 0
    v_mov_b32 v56, 0
    v_mov_b32 v57, 0
    v_mov_b32 v58, 0
    v_mov_b32 v59, 0
    v_mov_b32 v60, 0
    v_mov_b32 v61, 0
    v_mov_b32 v62, 0
    v_mov_b32 v63, 0
    v_mov_b32 v64, 0
    v_mov_b32 v65, 0
    v_mov_b32 v66, 0
    v_mov_b32 v67, 0
    v_mov_b32 v68, 0
    v_mov_b32 v69, 0
    v_mov_b32 v70, 0
    v_mov_b32 v71, 0
    v_mov_b32 v72, 0
    v_mov_b32 v73, 0
    v_mov_b32 v74, 0
    v_mov_b32 v75, 0
    v_mov_b32 v76, 0
    v_mov_b32 v77, 0
    v_mov_b32 v78, 0
    v_mov_b32 v79, 0
    v_mov_b32 v44, 0
    v_mov_b32 v45, 0
    v_mov_b32 v46, 0
    v_mov_b32 v47, 0
    s_mov_b32 s54, 8
    s_mov_b32 s56, 0
    s_waitcnt vmcnt(0)
    s_barrier
    s_mul_i32 s30, s3, 26
    s_lshr_b32 s30, s30, 8
    s_mul_i32 s29, s30, 10
    s_sub_u32 s64, s3, s29
    s_and_b32 s63, s2, 7
    s_lshl_b32 s63, s63, 8
    s_mul_i32 s29, s30, 96
    s_add_u32 s63, s63, s29
    s_cmp_eq_u32 s30, 2
    s_cselect_b32 s65, 64, 96
    s_cmp_ge_u32 s24, 3
    s_cselect_b32 s66, 1, 0
    s_mul_i32 s29, s66, 3
    s_sub_u32 s29, s24, s29
    s_lshr_b32 s67, s63, 5
    s_add_u32 s67, s67, s29
    s_lshl_b32 s29, s29, 5
    s_cmp_lt_u32 s29, s65
    s_cselect_b32 s67, s67, 64
    s_lshl_b32 s68, s64, 7
    s_lshl_b32 s30, s66, 6
    s_add_u32 s68, s68, s30
    v_and_b32 v125, 31, v1
    s_lshl_b32 s29, s67, 5
    v_add_u32 v125, s29, v125
    v_mul_u32_u24 v124, 1280, v125
    v_lshrrev_b32 v2, 5, v1
    v_lshl_add_u32 v124, v2, 4, v124
    v_lshlrev_b32 v120, 4, v125
    v_lshlrev_b32 v121, 2, v1
    buffer_load_dwordx4 v[112:115], v124, s[32:35], s68 offen
    buffer_load_dwordx4 v[116:119], v124, s[32:35], s68 offen offset:32
    s_setprio 1
    s_barrier
    buffer_load_dwordx4 v[16:19], v9, s[40:43], s59 offen sc1
    buffer_load_dwordx2 v[24:25], v6, s[40:43], s59 offen sc1
    buffer_load_dwordx4 v[20:23], v9, s[40:43], s31 offen sc1
    buffer_load_dwordx2 v[26:27], v6, s[40:43], s31 offen sc1
    s_waitcnt vmcnt(0)
    v_cndmask_b32 v24, v24, 0, s[52:53]
    v_cndmask_b32 v25, v25, 0, s[52:53]
    v_cndmask_b32 v26, v26, 0, s[52:53]
    v_cndmask_b32 v27, v27, 0, s[52:53]
    s_barrier
    ds_read_b128 v[28:31], v9
    v_add_u32 v9, s62, v9
    v_add_u32 v10, s62, v10
    s_waitcnt lgkmcnt(0)
    v_mfma_f32_32x32x16_bf16 v[80:95], v[28:31], v[16:19], 0
    v_mfma_f32_32x32x16_bf16 v[96:111], v[28:31], v[20:23], 0
    ds_read_b128 v[28:31], v9 offset:0
    ds_read_b64 v[14:15], v10 offset:0
    ds_read_b128 v[32:35], v11 offset:0
    ds_read_b128 v[40:43], v11 offset:704
    s_nop 1
    v_max3_f32 v2, v80, v81, v82
    v_max3_f32 v2, v2, v83, v84
    v_max3_f32 v2, v2, v85, v86
    v_max3_f32 v2, v2, v87, v88
    v_max3_f32 v2, v2, v89, v90
    v_max3_f32 v2, v2, v91, v92
    v_max3_f32 v2, v2, v93, v94
    v_max_f32 v2, v2, v95
    v_mov_b32 v4, v2
    s_nop 1
    v_permlane32_swap_b32 v4, v2
    s_nop 1
    v_max_f32 v2, v4, v2
    v_cvt_pk_bf16_f32 v2, -v2, 0
    v_cndmask_b32 v24, v24, v2, s[52:53]
    s_waitcnt lgkmcnt(2)
    v_mfma_f32_32x32x16_bf16 v[80:95], v[28:31], v[16:19], 0
    v_mfma_f32_32x32x8_bf16 v[80:95], v[14:15], v[24:25], v[80:95]
    v_max3_f32 v2, v96, v97, v98
    v_max3_f32 v2, v2, v99, v100
    v_max3_f32 v2, v2, v101, v102
    v_max3_f32 v2, v2, v103, v104
    v_max3_f32 v2, v2, v105, v106
    v_max3_f32 v2, v2, v107, v108
    v_max3_f32 v2, v2, v109, v110
    v_max_f32 v2, v2, v111
    v_mov_b32 v4, v2
    s_nop 1
    v_permlane32_swap_b32 v4, v2
    s_nop 1
    v_max_f32 v2, v4, v2
    v_cvt_pk_bf16_f32 v2, -v2, 0
    v_cndmask_b32 v26, v26, v2, s[52:53]
    v_mov_b32 v104, 0
    v_mov_b32 v105, 0
    v_mov_b32 v106, 0
    v_mov_b32 v107, 0
    v_mov_b32 v108, 0
    v_mov_b32 v109, 0
    v_mov_b32 v110, 0
    v_mov_b32 v111, 0
    s_waitcnt lgkmcnt(0)
    s_xor_b32 s59, s58, 1
    s_mul_i32 s59, s59, 40960
    s_add_u32 s59, s59, s61
    s_add_u32 s59, s59, 7872512
    s_mov_b32 s29, 10493952
    s_mov_b32 s30, 10526720
    s_barrier
    buffer_load_dwordx2 v[122:123], v120, s[40:43], s29 offen sc1
    buffer_load_dword v126, v121, s[40:43], s30 offen sc1
.p2align 6
L2_loop:
    v_exp_f32 v80, v80
    v_exp_f32 v81, v81
    v_smfmac_f32_32x32x32_bf16 v[64:79], v[44:47], v[104:111], v12
    ds_read_b128 v[36:39], v11 offset:2944
    ds_read_b128 v[44:47], v11 offset:3648
    v_exp_f32 v82, v82
    v_exp_f32 v83, v83
    v_mfma_f32_32x32x8_bf16 v[96:111], v[14:15], v[26:27], 0
    v_exp_f32 v84, v84
    v_exp_f32 v85, v85
    v_exp_f32 v86, v86
    v_exp_f32 v87, v87
    v_exp_f32 v88, v88
    v_mfma_f32_32x32x16_bf16 v[96:111], v[28:31], v[20:23], v[96:111]
    ds_read_b128 v[28:31], v9 offset:2944
    ds_read_b64 v[14:15], v10 offset:2944
    v_exp_f32 v89, v89
    v_exp_f32 v90, v90
    v_exp_f32 v91, v91
    v_exp_f32 v92, v92
    v_smfmac_f32_32x32x32_bf16 v[48:63], v[32:35], v[80:87], v12
    v_exp_f32 v93, v93
    v_exp_f32 v94, v94
    v_exp_f32 v95, v95
    v_exp_f32 v96, v96
    v_exp_f32 v97, v97
    v_smfmac_f32_32x32x32_bf16 v[48:63], v[40:43], v[88:95], v12
    v_exp_f32 v98, v98
    v_exp_f32 v99, v99
    s_waitcnt lgkmcnt(0)
    v_mfma_f32_32x32x8_bf16 v[80:95], v[14:15], v[24:25], 0
    v_exp_f32 v100, v100
    v_exp_f32 v101, v101
    v_exp_f32 v102, v102
    v_exp_f32 v103, v103
    v_exp_f32 v104, v104
    v_mfma_f32_32x32x16_bf16 v[80:95], v[28:31], v[16:19], v[80:95]
    v_exp_f32 v105, v105
    v_exp_f32 v106, v106
    v_exp_f32 v107, v107
    v_exp_f32 v108, v108
    v_smfmac_f32_32x32x32_bf16 v[64:79], v[32:35], v[96:103], v12
    v_exp_f32 v109, v109
    v_exp_f32 v110, v110
    v_exp_f32 v111, v111
    v_exp_f32 v80, v80
    v_exp_f32 v81, v81
    v_smfmac_f32_32x32x32_bf16 v[64:79], v[40:43], v[104:111], v12
    ds_read_b128 v[32:35], v11 offset:5888
    ds_read_b128 v[40:43], v11 offset:6592
    v_exp_f32 v82, v82
    v_exp_f32 v83, v83
    v_mfma_f32_32x32x8_bf16 v[96:111], v[14:15], v[26:27], 0
    v_exp_f32 v84, v84
    v_exp_f32 v85, v85
    v_exp_f32 v86, v86
    v_exp_f32 v87, v87
    v_exp_f32 v88, v88
    v_mfma_f32_32x32x16_bf16 v[96:111], v[28:31], v[20:23], v[96:111]
    ds_read_b128 v[28:31], v9 offset:5888
    ds_read_b64 v[14:15], v10 offset:5888
    v_exp_f32 v89, v89
    v_exp_f32 v90, v90
    v_exp_f32 v91, v91
    v_exp_f32 v92, v92
    v_smfmac_f32_32x32x32_bf16 v[48:63], v[36:39], v[80:87], v12
    v_exp_f32 v93, v93
    v_exp_f32 v94, v94
    v_exp_f32 v95, v95
    v_exp_f32 v96, v96
    v_exp_f32 v97, v97
    v_smfmac_f32_32x32x32_bf16 v[48:63], v[44:47], v[88:95], v12
    s_add_u32 s56, s56, 1
    s_cmp_eq_u32 s56, 3
    s_cselect_b32 s55, 4294920192, s60
    s_cselect_b32 s56, 0, s56
    s_sub_u32 s54, s54, 1
    v_exp_f32 v98, v98
    v_exp_f32 v99, v99
    s_waitcnt lgkmcnt(0)
    v_mfma_f32_32x32x8_bf16 v[80:95], v[14:15], v[24:25], 0
    v_exp_f32 v100, v100
    v_exp_f32 v101, v101
    v_exp_f32 v102, v102
    v_exp_f32 v103, v103
    v_exp_f32 v104, v104
    v_mfma_f32_32x32x16_bf16 v[80:95], v[28:31], v[16:19], v[80:95]
    v_exp_f32 v105, v105
    v_exp_f32 v106, v106
    v_exp_f32 v107, v107
    v_exp_f32 v108, v108
    v_smfmac_f32_32x32x32_bf16 v[64:79], v[36:39], v[96:103], v12
    v_exp_f32 v109, v109
    v_exp_f32 v110, v110
    v_exp_f32 v111, v111
    v_exp_f32 v80, v80
    v_exp_f32 v81, v81
    v_smfmac_f32_32x32x32_bf16 v[64:79], v[44:47], v[104:111], v12
    ds_read_b128 v[36:39], v11 offset:8832
    ds_read_b128 v[44:47], v11 offset:9536
    v_add_u32 v11, s55, v11
    v_exp_f32 v82, v82
    v_exp_f32 v83, v83
    v_mfma_f32_32x32x8_bf16 v[96:111], v[14:15], v[26:27], 0
    v_exp_f32 v84, v84
    v_exp_f32 v85, v85
    v_exp_f32 v86, v86
    v_exp_f32 v87, v87
    v_exp_f32 v88, v88
    v_mfma_f32_32x32x16_bf16 v[96:111], v[28:31], v[20:23], v[96:111]
    ds_read_b128 v[28:31], v9 offset:8832
    ds_read_b64 v[14:15], v10 offset:8832
    v_add_u32 v9, s55, v9
    v_add_u32 v10, s55, v10
    v_exp_f32 v89, v89
    v_exp_f32 v90, v90
    v_exp_f32 v91, v91
    v_exp_f32 v92, v92
    v_smfmac_f32_32x32x32_bf16 v[48:63], v[32:35], v[80:87], v12
    v_exp_f32 v93, v93
    v_exp_f32 v94, v94
    v_exp_f32 v95, v95
    v_exp_f32 v96, v96
    v_exp_f32 v97, v97
    v_smfmac_f32_32x32x32_bf16 v[48:63], v[40:43], v[88:95], v12
    v_exp_f32 v98, v98
    v_exp_f32 v99, v99
    s_waitcnt lgkmcnt(0)
    v_mfma_f32_32x32x8_bf16 v[80:95], v[14:15], v[24:25], 0
    v_exp_f32 v100, v100
    v_exp_f32 v101, v101
    v_exp_f32 v102, v102
    v_exp_f32 v103, v103
    v_exp_f32 v104, v104
    v_mfma_f32_32x32x16_bf16 v[80:95], v[28:31], v[16:19], v[80:95]
    v_exp_f32 v105, v105
    v_exp_f32 v106, v106
    v_exp_f32 v107, v107
    v_exp_f32 v108, v108
    v_smfmac_f32_32x32x32_bf16 v[64:79], v[32:35], v[96:103], v12
    v_exp_f32 v109, v109
    v_exp_f32 v110, v110
    v_exp_f32 v111, v111
    v_exp_f32 v80, v80
    v_exp_f32 v81, v81
    v_smfmac_f32_32x32x32_bf16 v[64:79], v[40:43], v[104:111], v12
    s_barrier
    ds_read_b128 v[32:35], v11 offset:0
    ds_read_b128 v[40:43], v11 offset:704
    v_exp_f32 v82, v82
    v_exp_f32 v83, v83
    v_mfma_f32_32x32x8_bf16 v[96:111], v[14:15], v[26:27], 0
    v_exp_f32 v84, v84
    v_exp_f32 v85, v85
    v_exp_f32 v86, v86
    v_exp_f32 v87, v87
    v_exp_f32 v88, v88
    v_mfma_f32_32x32x16_bf16 v[96:111], v[28:31], v[20:23], v[96:111]
    ds_read_b128 v[28:31], v9 offset:0
    ds_read_b64 v[14:15], v10 offset:0
    v_exp_f32 v89, v89
    v_exp_f32 v90, v90
    v_exp_f32 v91, v91
    v_exp_f32 v92, v92
    v_smfmac_f32_32x32x32_bf16 v[48:63], v[36:39], v[80:87], v12
    v_exp_f32 v93, v93
    v_exp_f32 v94, v94
    v_exp_f32 v95, v95
    v_exp_f32 v96, v96
    v_exp_f32 v97, v97
    v_smfmac_f32_32x32x32_bf16 v[48:63], v[44:47], v[88:95], v12
    v_exp_f32 v98, v98
    v_exp_f32 v99, v99
    s_waitcnt lgkmcnt(0)
    v_mfma_f32_32x32x8_bf16 v[80:95], v[14:15], v[24:25], 0
    v_exp_f32 v100, v100
    v_exp_f32 v101, v101
    v_exp_f32 v102, v102
    v_exp_f32 v103, v103
    v_exp_f32 v104, v104
    v_mfma_f32_32x32x16_bf16 v[80:95], v[28:31], v[16:19], v[80:95]
    v_exp_f32 v105, v105
    v_exp_f32 v106, v106
    v_exp_f32 v107, v107
    v_exp_f32 v108, v108
    v_smfmac_f32_32x32x32_bf16 v[64:79], v[36:39], v[96:103], v12
    s_cmp_lg_u32 s54, 0
    v_exp_f32 v109, v109
    v_exp_f32 v110, v110
    v_exp_f32 v111, v111
    s_cbranch_scc1 L2_loop
    s_nop 0
    v_smfmac_f32_32x32x32_bf16 v[64:79], v[44:47], v[104:111], v12
    ds_write_b128 v127, v[48:51] offset:0
    ds_write_b128 v127, v[52:55] offset:1024
    ds_write_b128 v127, v[56:59] offset:2048
    s_lshl_b32 s29, s57, 9
    v_lshl_add_u32 v9, v1, 4, s29
    s_mov_b32 s29, 0x32000000
    s_mov_b32 s30, 0x64000000
    s_mov_b32 s31, 0x21800000
    s_waitcnt lgkmcnt(0)
    s_barrier
    ds_read_b128 v[88:91], v128 offset:2048
    ds_read_b128 v[80:83], v128 offset:0
    ds_read_b128 v[84:87], v128 offset:1024
    s_waitcnt lgkmcnt(2)
    v_pk_add_f32 v[72:73], v[72:73], v[88:89]
    v_pk_add_f32 v[74:75], v[74:75], v[90:91]
    v_mov_b32 v2, v72
    v_mov_b32 v3, v72
    s_waitcnt lgkmcnt(1)
    v_pk_add_f32 v[64:65], v[64:65], v[80:81]
    v_pk_add_f32 v[66:67], v[66:67], v[82:83]
    v_permlane32_swap_b32 v2, v3
    s_waitcnt lgkmcnt(0)
    v_pk_add_f32 v[68:69], v[68:69], v[84:85]
    v_pk_add_f32 v[70:71], v[70:71], v[86:87]
    v_rcp_f32 v2, v3
    s_nop 0
    v_pk_mul_f32 v[96:97], v[2:3], v[64:65] op_sel_hi:[0,1]
    v_pk_mul_f32 v[98:99], v[2:3], v[66:67] op_sel_hi:[0,1]
    v_pk_mul_f32 v[100:101], v[2:3], v[68:69] op_sel_hi:[0,1]
    v_pk_mul_f32 v[102:103], v[2:3], v[70:71] op_sel_hi:[0,1]
    v_pk_mul_f32 v[104:105], v[2:3], v[72:73] op_sel_hi:[0,1]
    v_pk_mul_f32 v[106:107], v[2:3], v[74:75] op_sel_hi:[0,1]
    v_cvt_pk_bf16_f32 v96, v96, v97
    v_cvt_pk_bf16_f32 v97, v98, v99
    v_cvt_pk_bf16_f32 v98, v100, v101
    v_cvt_pk_bf16_f32 v99, v102, v103
    v_cvt_pk_bf16_f32 v100, v104, v105
    v_cvt_pk_bf16_f32 v101, v106, v107
    v_permlane32_swap_b32 v96, v98
    v_permlane32_swap_b32 v97, v99
    buffer_store_dwordx4 v[96:99], v9, s[40:43], s59 offen sc1
    s_mov_b32 exec_hi, 0
    buffer_store_dwordx2 v[100:101], v6, s[40:43], s59 offen sc1
    s_mov_b64 exec, -1
    v_mul_f32 v2, |v64|, s29
    v_mul_f32 v3, |v65|, s29
    v_fma_f32 v2, |v66|, s29, v2
    v_fma_f32 v3, |v67|, s29, v3
    v_fma_f32 v2, |v68|, s29, v2
    v_fma_f32 v3, |v69|, s29, v3
    v_fma_f32 v2, |v70|, s29, v2
    v_fma_f32 v3, |v71|, s29, v3
    v_fma_f32 v2, |v72|, s29, v2
    v_fma_f32 v3, |v73|, s29, v3
    v_fma_f32 v2, |v74|, s29, v2
    v_fma_f32 v3, |v75|, s29, v3
    v_cmp_gt_f32 s[54:55], s31, v72
    v_add_f32 v2, v2, v3
    v_cmp_nle_f32 vcc, v2, s30
    s_mov_b32 s54, 0
    s_or_b64 vcc, vcc, s[54:55]
    s_cbranch_vccnz L2_fallback
L2_stored:
    v_lshrrev_b32 v8, 5, v1
    v_lshlrev_b32 v7, 4, v1
    s_lshr_b32 s54, s64, 1
    s_add_u32 s44, s8, 7872512
    s_addc_u32 s45, s9, 0
    s_mov_b32 s46, 2621440
    s_mov_b32 s47, 0x20000
    s_mul_i32 s56, s67, 40960
    s_mul_i32 s29, s66, 20480
    s_add_u32 s56, s56, s29
    v_bfe_u32 v2, v1, 2, 2
    v_lshl_add_u32 v3, v8, 3, v2
    v_lshlrev_b32 v3, 7, v3
    v_lshrrev_b32 v2, 1, v2
    v_xor_b32 v2, s66, v2
    v_lshl_add_u32 v3, v2, 6, v3
    v_bfe_u32 v2, v1, 4, 1
    v_lshl_add_u32 v3, v2, 5, v3
    v_and_b32 v2, 3, v1
    v_lshl_add_u32 v3, v2, 3, v3
    v_xor_b32 v2, 64, v3
    s_mul_i32 s29, s66, 40960
    s_add_u32 s29, s29, 70656
    s_cmp_ge_u32 s24, 6
    s_cselect_b32 s30, 30, s3
    s_cmp_ge_u32 s30, 30
    s_waitcnt vmcnt(0)
    s_barrier
    s_cbranch_scc1 L3_out
    v_add_u32 v9, s29, v3
    v_add_u32 v10, s29, v2
    s_lshl_b32 s29, s24, 12
    v_add_u32 v2, s29, v7
    s_mul_i32 s30, s66, 4294942720
    s_add_u32 s29, s29, s30
    s_add_u32 s29, s29, 12288
    v_add_u32 v3, s29, v7
    v_mov_b32 v11, v124
    v_mov_b32 v12, v125
    v_readlane_b32 s16, v126, 0
    v_readlane_b32 s17, v126, 1
    v_readlane_b32 s18, v126, 2
    v_readlane_b32 s19, v126, 3
    v_readlane_b32 s20, v126, 4
    v_readlane_b32 s21, v126, 5
    v_readlane_b32 s22, v126, 6
    v_readlane_b32 s23, v126, 7
    s_mov_b32 s69, 0
    s_sub_u32 s29, s16, s63
    s_cmp_lt_u32 s29, s65
    s_cselect_b32 s29, 1, 0
    s_or_b32 s69, s69, s29
    s_sub_u32 s29, s17, s63
    s_cmp_lt_u32 s29, s65
    s_cselect_b32 s29, 2, 0
    s_or_b32 s69, s69, s29
    s_sub_u32 s29, s18, s63
    s_cmp_lt_u32 s29, s65
    s_cselect_b32 s29, 4, 0
    s_or_b32 s69, s69, s29
    s_sub_u32 s29, s19, s63
    s_cmp_lt_u32 s29, s65
    s_cselect_b32 s29, 8, 0
    s_or_b32 s69, s69, s29
    s_sub_u32 s29, s20, s63
    s_cmp_lt_u32 s29, s65
    s_cselect_b32 s29, 16, 0
    s_or_b32 s69, s69, s29
    s_sub_u32 s29, s21, s63
    s_cmp_lt_u32 s29, s65
    s_cselect_b32 s29, 32, 0
    s_or_b32 s69, s69, s29
    s_sub_u32 s29, s22, s63
    s_cmp_lt_u32 s29, s65
    s_cselect_b32 s29, 64, 0
    s_or_b32 s69, s69, s29
    s_sub_u32 s29, s23, s63
    s_cmp_lt_u32 s29, s65
    s_cselect_b32 s29, 128, 0
    s_or_b32 s69, s69, s29
    v_permlane32_swap_b32 v112, v114
    v_permlane32_swap_b32 v113, v115
    v_permlane32_swap_b32 v116, v118
    v_permlane32_swap_b32 v117, v119
    v_lshlrev_b32 v16, 16, v112
    v_and_b32 v17, 0xffff0000, v112
    v_lshlrev_b32 v18, 16, v113
    v_and_b32 v19, 0xffff0000, v113
    v_lshlrev_b32 v20, 16, v114
    v_and_b32 v21, 0xffff0000, v114
    v_lshlrev_b32 v22, 16, v115
    v_and_b32 v23, 0xffff0000, v115
    v_lshlrev_b32 v24, 16, v116
    v_and_b32 v25, 0xffff0000, v116
    v_lshlrev_b32 v26, 16, v117
    v_and_b32 v27, 0xffff0000, v117
    v_lshlrev_b32 v28, 16, v118
    v_and_b32 v29, 0xffff0000, v118
    v_lshlrev_b32 v30, 16, v119
    v_and_b32 v31, 0xffff0000, v119
    v_pk_add_f32 v[32:33], v[16:17], v[122:123] op_sel_hi:[1,0] neg_lo:[0,1] neg_hi:[0,1]
    v_pk_add_f32 v[34:35], v[18:19], v[122:123] op_sel_hi:[1,0] neg_lo:[0,1] neg_hi:[0,1]
    v_pk_add_f32 v[36:37], v[20:21], v[122:123] op_sel_hi:[1,0] neg_lo:[0,1] neg_hi:[0,1]
    v_pk_add_f32 v[38:39], v[22:23], v[122:123] op_sel_hi:[1,0] neg_lo:[0,1] neg_hi:[0,1]
    v_pk_add_f32 v[40:41], v[24:25], v[122:123] op_sel_hi:[1,0] neg_lo:[0,1] neg_hi:[0,1]
    v_pk_add_f32 v[42:43], v[26:27], v[122:123] op_sel_hi:[1,0] neg_lo:[0,1] neg_hi:[0,1]
    v_pk_add_f32 v[44:45], v[28:29], v[122:123] op_sel_hi:[1,0] neg_lo:[0,1] neg_hi:[0,1]
    v_pk_add_f32 v[46:47], v[30:31], v[122:123] op_sel_hi:[1,0] neg_lo:[0,1] neg_hi:[0,1]
    v_cvt_pk_bf16_f32 v160, v32, v33
    v_cvt_pk_bf16_f32 v161, v34, v35
    v_cvt_pk_bf16_f32 v162, v36, v37
    v_cvt_pk_bf16_f32 v163, v38, v39
    v_cvt_pk_bf16_f32 v164, v40, v41
    v_cvt_pk_bf16_f32 v165, v42, v43
    v_cvt_pk_bf16_f32 v166, v44, v45
    v_cvt_pk_bf16_f32 v167, v46, v47
    v_lshlrev_b32 v32, 16, v160
    v_and_b32 v33, 0xffff0000, v160
    v_lshlrev_b32 v34, 16, v161
    v_and_b32 v35, 0xffff0000, v161
    v_lshlrev_b32 v36, 16, v162
    v_and_b32 v37, 0xffff0000, v162
    v_lshlrev_b32 v38, 16, v163
    v_and_b32 v39, 0xffff0000, v163
    v_lshlrev_b32 v40, 16, v164
    v_and_b32 v41, 0xffff0000, v164
    v_lshlrev_b32 v42, 16, v165
    v_and_b32 v43, 0xffff0000, v165
    v_lshlrev_b32 v44, 16, v166
    v_and_b32 v45, 0xffff0000, v166
    v_lshlrev_b32 v46, 16, v167
    v_and_b32 v47, 0xffff0000, v167
    v_pk_mul_f32 v[32:33], v[32:33], v[122:123] op_sel:[0,1] op_sel_hi:[1,1]
    v_pk_mul_f32 v[34:35], v[34:35], v[122:123] op_sel:[0,1] op_sel_hi:[1,1]
    v_pk_mul_f32 v[36:37], v[36:37], v[122:123] op_sel:[0,1] op_sel_hi:[1,1]
    v_pk_mul_f32 v[38:39], v[38:39], v[122:123] op_sel:[0,1] op_sel_hi:[1,1]
    v_pk_mul_f32 v[40:41], v[40:41], v[122:123] op_sel:[0,1] op_sel_hi:[1,1]
    v_pk_mul_f32 v[42:43], v[42:43], v[122:123] op_sel:[0,1] op_sel_hi:[1,1]
    v_pk_mul_f32 v[44:45], v[44:45], v[122:123] op_sel:[0,1] op_sel_hi:[1,1]
    v_pk_mul_f32 v[46:47], v[46:47], v[122:123] op_sel:[0,1] op_sel_hi:[1,1]
    v_cvt_pk_bf16_f32 v160, v32, v33
    v_cvt_pk_bf16_f32 v161, v34, v35
    v_cvt_pk_bf16_f32 v162, v36, v37
    v_cvt_pk_bf16_f32 v163, v38, v39
    v_cvt_pk_bf16_f32 v164, v40, v41
    v_cvt_pk_bf16_f32 v165, v42, v43
    v_cvt_pk_bf16_f32 v166, v44, v45
    v_cvt_pk_bf16_f32 v167, v46, v47
    v_lshlrev_b32 v32, 16, v160
    v_and_b32 v33, 0xffff0000, v160
    v_lshlrev_b32 v34, 16, v161
    v_and_b32 v35, 0xffff0000, v161
    v_lshlrev_b32 v36, 16, v162
    v_and_b32 v37, 0xffff0000, v162
    v_lshlrev_b32 v38, 16, v163
    v_and_b32 v39, 0xffff0000, v163
    v_lshlrev_b32 v40, 16, v164
    v_and_b32 v41, 0xffff0000, v164
    v_lshlrev_b32 v42, 16, v165
    v_and_b32 v43, 0xffff0000, v165
    v_lshlrev_b32 v44, 16, v166
    v_and_b32 v45, 0xffff0000, v166
    v_lshlrev_b32 v46, 16, v167
    v_and_b32 v47, 0xffff0000, v167
    s_cmp_eq_u32 s69, 0
    s_cbranch_scc0 L3_updaddr
L3_updaddr_ret:
    s_mov_b32 s57, s54
    s_lshl_b32 s55, s57, 12
    s_add_u32 s55, s55, s56
    s_add_u32 s57, s57, 1
    s_cmp_eq_u32 s57, 5
    s_cselect_b32 s57, 0, s57
    s_lshl_b32 s29, s54, 13
    v_add_u32 v14, s29, v9
    v_add_u32 v15, s29, v10
    s_add_u32 s54, s54, 1
    s_cmp_eq_u32 s54, 5
    s_cselect_b32 s54, 0, s54
    s_barrier
L3_again:
    buffer_load_dwordx4 v[96:99], v7, s[44:47], s55 offen offset:0 sc1
    buffer_load_dwordx4 v[100:103], v7, s[44:47], s55 offen offset:1024 sc1
    buffer_load_dwordx4 v[104:107], v7, s[44:47], s55 offen offset:2048 sc1
    buffer_load_dwordx4 v[108:111], v7, s[44:47], s55 offen offset:3072 sc1
    s_lshl_b32 s55, s57, 12
    s_add_u32 s55, s55, s56
    s_add_u32 s57, s57, 1
    s_cmp_eq_u32 s57, 5
    s_cselect_b32 s57, 0, s57
    buffer_load_dwordx4 v[112:115], v7, s[44:47], s55 offen offset:0 sc1
    buffer_load_dwordx4 v[116:119], v7, s[44:47], s55 offen offset:1024 sc1
    buffer_load_dwordx4 v[120:123], v7, s[44:47], s55 offen offset:2048 sc1
    buffer_load_dwordx4 v[124:127], v7, s[44:47], s55 offen offset:3072 sc1
    s_cmp_eq_u32 s69, 0
    s_cbranch_scc0 L3_upd
L3_noupd:
    ds_read_b64_tr_b16 v[80:81], v14 offset:0
    ds_read_b64_tr_b16 v[82:83], v14 offset:512
    ds_read_b64_tr_b16 v[84:85], v15 offset:0
    ds_read_b64_tr_b16 v[86:87], v15 offset:512
    v_pk_add_f32 v[16:17], v[16:17], v[32:33]
    v_pk_add_f32 v[18:19], v[18:19], v[34:35]
    v_pk_add_f32 v[20:21], v[20:21], v[36:37]
    v_pk_add_f32 v[22:23], v[22:23], v[38:39]
    v_pk_add_f32 v[24:25], v[24:25], v[40:41]
    v_pk_add_f32 v[26:27], v[26:27], v[42:43]
    v_pk_add_f32 v[28:29], v[28:29], v[44:45]
    v_pk_add_f32 v[30:31], v[30:31], v[46:47]
    s_waitcnt vmcnt(7) lgkmcnt(2)
    v_mfma_f32_32x32x16_bf16 v[48:63], v[80:83], v[96:99], 0
    ds_read_b64_tr_b16 v[88:89], v14 offset:2048
    ds_read_b64_tr_b16 v[90:91], v14 offset:2560
    s_waitcnt lgkmcnt(2)
    v_mfma_f32_32x32x16_bf16 v[64:79], v[84:87], v[96:99], 0
    ds_read_b64_tr_b16 v[92:93], v15 offset:2048
    ds_read_b64_tr_b16 v[94:95], v15 offset:2560
    s_lshl_b32 s55, s57, 12
    s_add_u32 s55, s55, s56
    s_add_u32 s57, s57, 1
    s_cmp_eq_u32 s57, 5
    s_cselect_b32 s57, 0, s57
    buffer_load_dwordx4 v[128:131], v7, s[44:47], s55 offen offset:0 sc1
    s_waitcnt vmcnt(7) lgkmcnt(2)
    v_mfma_f32_32x32x16_bf16 v[48:63], v[88:91], v[100:103], v[48:63]
    ds_read_b64_tr_b16 v[80:81], v14 offset:4096
    ds_read_b64_tr_b16 v[82:83], v14 offset:4608
    s_waitcnt lgkmcnt(2)
    v_mfma_f32_32x32x16_bf16 v[64:79], v[92:95], v[100:103], v[64:79]
    ds_read_b64_tr_b16 v[84:85], v15 offset:4096
    ds_read_b64_tr_b16 v[86:87], v15 offset:4608
    buffer_load_dwordx4 v[132:135], v7, s[44:47], s55 offen offset:1024 sc1
    s_waitcnt vmcnt(7) lgkmcnt(2)
    v_mfma_f32_32x32x16_bf16 v[48:63], v[80:83], v[104:107], v[48:63]
    ds_read_b64_tr_b16 v[88:89], v14 offset:6144
    ds_read_b64_tr_b16 v[90:91], v14 offset:6656
    s_waitcnt lgkmcnt(2)
    v_mfma_f32_32x32x16_bf16 v[64:79], v[84:87], v[104:107], v[64:79]
    ds_read_b64_tr_b16 v[92:93], v15 offset:6144
    ds_read_b64_tr_b16 v[94:95], v15 offset:6656
    buffer_load_dwordx4 v[136:139], v7, s[44:47], s55 offen offset:2048 sc1
    s_waitcnt vmcnt(7) lgkmcnt(2)
    v_mfma_f32_32x32x16_bf16 v[48:63], v[88:91], v[108:111], v[48:63]
    s_lshl_b32 s29, s54, 13
    v_add_u32 v14, s29, v9
    v_add_u32 v15, s29, v10
    s_add_u32 s54, s54, 1
    s_cmp_eq_u32 s54, 5
    s_cselect_b32 s54, 0, s54
    ds_read_b64_tr_b16 v[80:81], v14 offset:0
    ds_read_b64_tr_b16 v[82:83], v14 offset:512
    s_waitcnt lgkmcnt(2)
    v_mfma_f32_32x32x16_bf16 v[64:79], v[92:95], v[108:111], v[64:79]
    ds_read_b64_tr_b16 v[84:85], v15 offset:0
    ds_read_b64_tr_b16 v[86:87], v15 offset:512
    buffer_load_dwordx4 v[140:143], v7, s[44:47], s55 offen offset:3072 sc1
    s_waitcnt vmcnt(7) lgkmcnt(2)
    v_mfma_f32_32x32x16_bf16 v[48:63], v[80:83], v[112:115], v[48:63]
    ds_read_b64_tr_b16 v[88:89], v14 offset:2048
    ds_read_b64_tr_b16 v[90:91], v14 offset:2560
    s_waitcnt lgkmcnt(2)
    v_mfma_f32_32x32x16_bf16 v[64:79], v[84:87], v[112:115], v[64:79]
    ds_read_b64_tr_b16 v[92:93], v15 offset:2048
    ds_read_b64_tr_b16 v[94:95], v15 offset:2560
    s_lshl_b32 s55, s57, 12
    s_add_u32 s55, s55, s56
    s_add_u32 s57, s57, 1
    s_cmp_eq_u32 s57, 5
    s_cselect_b32 s57, 0, s57
    buffer_load_dwordx4 v[144:147], v7, s[44:47], s55 offen offset:0 sc1
    s_waitcnt vmcnt(7) lgkmcnt(2)
    v_mfma_f32_32x32x16_bf16 v[48:63], v[88:91], v[116:119], v[48:63]
    ds_read_b64_tr_b16 v[80:81], v14 offset:4096
    ds_read_b64_tr_b16 v[82:83], v14 offset:4608
    s_waitcnt lgkmcnt(2)
    v_mfma_f32_32x32x16_bf16 v[64:79], v[92:95], v[116:119], v[64:79]
    ds_read_b64_tr_b16 v[84:85], v15 offset:4096
    ds_read_b64_tr_b16 v[86:87], v15 offset:4608
    buffer_load_dwordx4 v[148:151], v7, s[44:47], s55 offen offset:1024 sc1
    s_waitcnt vmcnt(7) lgkmcnt(2)
    v_mfma_f32_32x32x16_bf16 v[48:63], v[80:83], v[120:123], v[48:63]
    ds_read_b64_tr_b16 v[88:89], v14 offset:6144
    ds_read_b64_tr_b16 v[90:91], v14 offset:6656
    s_waitcnt lgkmcnt(2)
    v_mfma_f32_32x32x16_bf16 v[64:79], v[84:87], v[120:123], v[64:79]
    ds_read_b64_tr_b16 v[92:93], v15 offset:6144
    ds_read_b64_tr_b16 v[94:95], v15 offset:6656
    buffer_load_dwordx4 v[152:155], v7, s[44:47], s55 offen offset:2048 sc1
    s_waitcnt vmcnt(7) lgkmcnt(2)
    v_mfma_f32_32x32x16_bf16 v[48:63], v[88:91], v[124:127], v[48:63]
    s_lshl_b32 s29, s54, 13
    v_add_u32 v14, s29, v9
    v_add_u32 v15, s29, v10
    s_add_u32 s54, s54, 1
    s_cmp_eq_u32 s54, 5
    s_cselect_b32 s54, 0, s54
    ds_read_b64_tr_b16 v[80:81], v14 offset:0
    ds_read_b64_tr_b16 v[82:83], v14 offset:512
    s_waitcnt lgkmcnt(2)
    v_mfma_f32_32x32x16_bf16 v[64:79], v[92:95], v[124:127], v[64:79]
    ds_read_b64_tr_b16 v[84:85], v15 offset:0
    ds_read_b64_tr_b16 v[86:87], v15 offset:512
    buffer_load_dwordx4 v[156:159], v7, s[44:47], s55 offen offset:3072 sc1
    s_waitcnt vmcnt(7) lgkmcnt(2)
    v_mfma_f32_32x32x16_bf16 v[48:63], v[80:83], v[128:131], v[48:63]
    ds_read_b64_tr_b16 v[88:89], v14 offset:2048
    ds_read_b64_tr_b16 v[90:91], v14 offset:2560
    s_waitcnt lgkmcnt(2)
    v_mfma_f32_32x32x16_bf16 v[64:79], v[84:87], v[128:131], v[64:79]
    ds_read_b64_tr_b16 v[92:93], v15 offset:2048
    ds_read_b64_tr_b16 v[94:95], v15 offset:2560
    s_lshl_b32 s55, s57, 12
    s_add_u32 s55, s55, s56
    s_add_u32 s57, s57, 1
    s_cmp_eq_u32 s57, 5
    s_cselect_b32 s57, 0, s57
    buffer_load_dwordx4 v[96:99], v7, s[44:47], s55 offen offset:0 sc1
    s_waitcnt vmcnt(7) lgkmcnt(2)
    v_mfma_f32_32x32x16_bf16 v[48:63], v[88:91], v[132:135], v[48:63]
    ds_read_b64_tr_b16 v[80:81], v14 offset:4096
    ds_read_b64_tr_b16 v[82:83], v14 offset:4608
    s_waitcnt lgkmcnt(2)
    v_mfma_f32_32x32x16_bf16 v[64:79], v[92:95], v[132:135], v[64:79]
    ds_read_b64_tr_b16 v[84:85], v15 offset:4096
    ds_read_b64_tr_b16 v[86:87], v15 offset:4608
    buffer_load_dwordx4 v[100:103], v7, s[44:47], s55 offen offset:1024 sc1
    s_waitcnt vmcnt(7) lgkmcnt(2)
    v_mfma_f32_32x32x16_bf16 v[48:63], v[80:83], v[136:139], v[48:63]
    ds_read_b64_tr_b16 v[88:89], v14 offset:6144
    ds_read_b64_tr_b16 v[90:91], v14 offset:6656
    s_waitcnt lgkmcnt(2)
    v_mfma_f32_32x32x16_bf16 v[64:79], v[84:87], v[136:139], v[64:79]
    ds_read_b64_tr_b16 v[92:93], v15 offset:6144
    ds_read_b64_tr_b16 v[94:95], v15 offset:6656
    buffer_load_dwordx4 v[104:107], v7, s[44:47], s55 offen offset:2048 sc1
    s_waitcnt vmcnt(7) lgkmcnt(2)
    v_mfma_f32_32x32x16_bf16 v[48:63], v[88:91], v[140:143], v[48:63]
    s_lshl_b32 s29, s54, 13
    v_add_u32 v14, s29, v9
    v_add_u32 v15, s29, v10
    s_add_u32 s54, s54, 1
    s_cmp_eq_u32 s54, 5
    s_cselect_b32 s54, 0, s54
    ds_read_b64_tr_b16 v[80:81], v14 offset:0
    ds_read_b64_tr_b16 v[82:83], v14 offset:512
    s_waitcnt lgkmcnt(2)
    v_mfma_f32_32x32x16_bf16 v[64:79], v[92:95], v[140:143], v[64:79]
    ds_read_b64_tr_b16 v[84:85], v15 offset:0
    ds_read_b64_tr_b16 v[86:87], v15 offset:512
    buffer_load_dwordx4 v[108:111], v7, s[44:47], s55 offen offset:3072 sc1
    s_waitcnt vmcnt(7) lgkmcnt(2)
    v_mfma_f32_32x32x16_bf16 v[48:63], v[80:83], v[144:147], v[48:63]
    ds_read_b64_tr_b16 v[88:89], v14 offset:2048
    ds_read_b64_tr_b16 v[90:91], v14 offset:2560
    s_waitcnt lgkmcnt(2)
    v_mfma_f32_32x32x16_bf16 v[64:79], v[84:87], v[144:147], v[64:79]
    ds_read_b64_tr_b16 v[92:93], v15 offset:2048
    ds_read_b64_tr_b16 v[94:95], v15 offset:2560
    s_waitcnt vmcnt(6) lgkmcnt(2)
    v_mfma_f32_32x32x16_bf16 v[48:63], v[88:91], v[148:151], v[48:63]
    ds_read_b64_tr_b16 v[80:81], v14 offset:4096
    ds_read_b64_tr_b16 v[82:83], v14 offset:4608
    s_waitcnt lgkmcnt(2)
    v_mfma_f32_32x32x16_bf16 v[64:79], v[92:95], v[148:151], v[64:79]
    ds_read_b64_tr_b16 v[84:85], v15 offset:4096
    ds_read_b64_tr_b16 v[86:87], v15 offset:4608
    s_waitcnt vmcnt(5) lgkmcnt(2)
    v_mfma_f32_32x32x16_bf16 v[48:63], v[80:83], v[152:155], v[48:63]
    ds_read_b64_tr_b16 v[88:89], v14 offset:6144
    ds_read_b64_tr_b16 v[90:91], v14 offset:6656
    s_waitcnt lgkmcnt(2)
    v_mfma_f32_32x32x16_bf16 v[64:79], v[84:87], v[152:155], v[64:79]
    ds_read_b64_tr_b16 v[92:93], v15 offset:6144
    ds_read_b64_tr_b16 v[94:95], v15 offset:6656
    s_waitcnt vmcnt(4) lgkmcnt(2)
    v_mfma_f32_32x32x16_bf16 v[48:63], v[88:91], v[156:159], v[48:63]
    s_lshl_b32 s29, s54, 13
    v_add_u32 v14, s29, v9
    v_add_u32 v15, s29, v10
    s_add_u32 s54, s54, 1
    s_cmp_eq_u32 s54, 5
    s_cselect_b32 s54, 0, s54
    ds_read_b64_tr_b16 v[80:81], v14 offset:0
    ds_read_b64_tr_b16 v[82:83], v14 offset:512
    s_waitcnt lgkmcnt(2)
    v_mfma_f32_32x32x16_bf16 v[64:79], v[92:95], v[156:159], v[64:79]
    ds_read_b64_tr_b16 v[84:85], v15 offset:0
    ds_read_b64_tr_b16 v[86:87], v15 offset:512
    s_waitcnt vmcnt(3) lgkmcnt(2)
    v_mfma_f32_32x32x16_bf16 v[48:63], v[80:83], v[96:99], v[48:63]
    ds_read_b64_tr_b16 v[88:89], v14 offset:2048
    ds_read_b64_tr_b16 v[90:91], v14 offset:2560
    s_waitcnt lgkmcnt(2)
    v_mfma_f32_32x32x16_bf16 v[64:79], v[84:87], v[96:99], v[64:79]
    ds_read_b64_tr_b16 v[92:93], v15 offset:2048
    ds_read_b64_tr_b16 v[94:95], v15 offset:2560
    s_waitcnt vmcnt(2) lgkmcnt(2)
    v_mfma_f32_32x32x16_bf16 v[48:63], v[88:91], v[100:103], v[48:63]
    ds_read_b64_tr_b16 v[80:81], v14 offset:4096
    ds_read_b64_tr_b16 v[82:83], v14 offset:4608
    s_waitcnt lgkmcnt(2)
    v_mfma_f32_32x32x16_bf16 v[64:79], v[92:95], v[100:103], v[64:79]
    ds_read_b64_tr_b16 v[84:85], v15 offset:4096
    ds_read_b64_tr_b16 v[86:87], v15 offset:4608
    s_waitcnt vmcnt(1) lgkmcnt(2)
    v_mfma_f32_32x32x16_bf16 v[48:63], v[80:83], v[104:107], v[48:63]
    ds_read_b64_tr_b16 v[88:89], v14 offset:6144
    ds_read_b64_tr_b16 v[90:91], v14 offset:6656
    s_waitcnt lgkmcnt(2)
    v_mfma_f32_32x32x16_bf16 v[64:79], v[84:87], v[104:107], v[64:79]
    ds_read_b64_tr_b16 v[92:93], v15 offset:6144
    ds_read_b64_tr_b16 v[94:95], v15 offset:6656
    s_waitcnt vmcnt(0) lgkmcnt(2)
    v_mfma_f32_32x32x16_bf16 v[48:63], v[88:91], v[108:111], v[48:63]
    s_waitcnt lgkmcnt(0)
    v_mfma_f32_32x32x16_bf16 v[64:79], v[92:95], v[108:111], v[64:79]
    s_nop 11
    ds_write_b128 v2, v[64:67] offset:0
    ds_write_b128 v2, v[68:71] offset:1024
    ds_write_b128 v2, v[72:75] offset:2048
    ds_write_b128 v2, v[76:79] offset:3072
    v_pk_add_f32 v[16:17], v[16:17], v[48:49]
    v_pk_add_f32 v[18:19], v[18:19], v[50:51]
    v_pk_add_f32 v[20:21], v[20:21], v[52:53]
    v_pk_add_f32 v[22:23], v[22:23], v[54:55]
    v_pk_add_f32 v[24:25], v[24:25], v[56:57]
    v_pk_add_f32 v[26:27], v[26:27], v[58:59]
    v_pk_add_f32 v[28:29], v[28:29], v[60:61]
    v_pk_add_f32 v[30:31], v[30:31], v[62:63]
    s_waitcnt lgkmcnt(0)
    s_barrier
    ds_read_b128 v[96:99], v3 offset:0
    ds_read_b128 v[100:103], v3 offset:1024
    ds_read_b128 v[104:107], v3 offset:2048
    ds_read_b128 v[108:111], v3 offset:3072
    s_waitcnt lgkmcnt(3)
    v_pk_add_f32 v[16:17], v[16:17], v[96:97]
    v_pk_add_f32 v[18:19], v[18:19], v[98:99]
    v_cvt_pk_bf16_f32 v160, v16, v17
    v_cvt_pk_bf16_f32 v161, v18, v19
    s_waitcnt lgkmcnt(2)
    v_pk_add_f32 v[20:21], v[20:21], v[100:101]
    v_pk_add_f32 v[22:23], v[22:23], v[102:103]
    v_cvt_pk_bf16_f32 v162, v20, v21
    v_cvt_pk_bf16_f32 v163, v22, v23
    s_waitcnt lgkmcnt(1)
    v_pk_add_f32 v[24:25], v[24:25], v[104:105]
    v_pk_add_f32 v[26:27], v[26:27], v[106:107]
    v_cvt_pk_bf16_f32 v164, v24, v25
    v_cvt_pk_bf16_f32 v165, v26, v27
    s_waitcnt lgkmcnt(0)
    v_pk_add_f32 v[28:29], v[28:29], v[108:109]
    v_pk_add_f32 v[30:31], v[30:31], v[110:111]
    v_cvt_pk_bf16_f32 v166, v28, v29
    v_cvt_pk_bf16_f32 v167, v30, v31
    s_nop 0
    v_permlane32_swap_b32 v160, v162
    v_permlane32_swap_b32 v161, v163
    v_permlane32_swap_b32 v164, v166
    v_permlane32_swap_b32 v165, v167
    buffer_store_dwordx4 v[160:163], v11, s[48:51], s68 offen
    buffer_store_dwordx4 v[164:167], v11, s[48:51], s68 offen offset:32
L3_out:
    s_endpgm
L3_updaddr:
    v_mov_b32 v4, 8
    v_cmp_ne_u32 vcc, s16, v12
    s_nop 1
    v_cndmask_b32 v4, 0, v4, vcc
    v_cmp_ne_u32 vcc, s17, v12
    s_nop 1
    v_cndmask_b32 v4, 1, v4, vcc
    v_cmp_ne_u32 vcc, s18, v12
    s_nop 1
    v_cndmask_b32 v4, 2, v4, vcc
    v_cmp_ne_u32 vcc, s19, v12
    s_nop 1
    v_cndmask_b32 v4, 3, v4, vcc
    v_cmp_ne_u32 vcc, s20, v12
    s_nop 1
    v_cndmask_b32 v4, 4, v4, vcc
    v_cmp_ne_u32 vcc, s21, v12
    s_nop 1
    v_cndmask_b32 v4, 5, v4, vcc
    v_cmp_ne_u32 vcc, s22, v12
    s_nop 1
    v_cndmask_b32 v4, 6, v4, vcc
    v_cmp_ne_u32 vcc, s23, v12
    s_nop 1
    v_cndmask_b32 v4, 7, v4, vcc
    s_lshl_b32 s29, s66, 7
    s_add_u32 s29, s29, 153088
    v_lshl_add_u32 v4, v4, 8, s29
    v_lshl_add_u32 v4, v8, 4, v4
    s_branch L3_updaddr_ret
L3_upd:
    ds_read_b128 v[80:83], v4 offset:0
    ds_read_b128 v[84:87], v4 offset:32
    ds_read_b128 v[88:91], v4 offset:64
    ds_read_b128 v[92:95], v4 offset:96
    s_waitcnt lgkmcnt(0)
    v_pk_add_f32 v[32:33], v[32:33], v[80:81]
    v_pk_add_f32 v[34:35], v[34:35], v[82:83]
    v_pk_add_f32 v[36:37], v[36:37], v[84:85]
    v_pk_add_f32 v[38:39], v[38:39], v[86:87]
    v_pk_add_f32 v[40:41], v[40:41], v[88:89]
    v_pk_add_f32 v[42:43], v[42:43], v[90:91]
    v_pk_add_f32 v[44:45], v[44:45], v[92:93]
    v_pk_add_f32 v[46:47], v[46:47], v[94:95]
    v_cvt_pk_bf16_f32 v160, v32, v33
    v_cvt_pk_bf16_f32 v161, v34, v35
    v_cvt_pk_bf16_f32 v162, v36, v37
    v_cvt_pk_bf16_f32 v163, v38, v39
    v_cvt_pk_bf16_f32 v164, v40, v41
    v_cvt_pk_bf16_f32 v165, v42, v43
    v_cvt_pk_bf16_f32 v166, v44, v45
    v_cvt_pk_bf16_f32 v167, v46, v47
    v_lshlrev_b32 v32, 16, v160
    v_and_b32 v33, 0xffff0000, v160
    v_lshlrev_b32 v34, 16, v161
    v_and_b32 v35, 0xffff0000, v161
    v_lshlrev_b32 v36, 16, v162
    v_and_b32 v37, 0xffff0000, v162
    v_lshlrev_b32 v38, 16, v163
    v_and_b32 v39, 0xffff0000, v163
    v_lshlrev_b32 v40, 16, v164
    v_and_b32 v41, 0xffff0000, v164
    v_lshlrev_b32 v42, 16, v165
    v_and_b32 v43, 0xffff0000, v165
    v_lshlrev_b32 v44, 16, v166
    v_and_b32 v45, 0xffff0000, v166
    v_lshlrev_b32 v46, 16, v167
    v_and_b32 v47, 0xffff0000, v167
    s_branch L3_noupd
L2_fallback:
    s_waitcnt vmcnt(0)
    s_mov_b32 s44, s8
    s_mov_b32 s45, s9
    s_mov_b32 s46, 5251072
    s_mov_b32 s47, 0x20000
    v_add_u32 v7, s61, v9
    v_add_u32 v8, s61, v6
    v_mov_b32 v4, 81920
    v_cndmask_b32 v8, v8, v4, s[52:53]
    s_mul_i32 s30, s27, 1280
    s_add_u32 s30, s30, 40960
    v_and_b32 v3, 31, v1
    s_lshl_b32 s29, s57, 2
    v_add_u32 v4, s29, v3
    v_subrev_u32 v5, 20, v4
    v_min_u32 v4, v4, v5
    v_cmp_gt_u32 vcc, 20, v3
    v_min_u32 v3, 21, v3
    v_lshrrev_b32 v5, 5, v1
    v_cndmask_b32 v3, v3, v4, vcc
    v_mul_u32_u24 v5, 320, v5
    v_lshl_add_u32 v11, v3, 4, v5
    v_cmp_gt_u32 vcc, 20, v3
    v_add_u32 v11, s30, v11
    v_lshlrev_b32 v3, 4, v3
    v_add_u32 v3, 81600, v3
    v_add_u32 v13, 640, v11
    v_cndmask_b32 v11, v3, v11, vcc
    v_cndmask_b32 v13, v3, v13, vcc
    v_cndmask_b32 v26, v26, 0, s[52:53]
    v_cndmask_b32 v27, v27, 0, s[52:53]
    v_mov_b32 v2, 0xff800000
    s_mov_b32 s29, 0
L2_fb_max:
    buffer_load_dwordx4 v[28:31], v7, s[44:47], s29 offen sc1
    buffer_load_dwordx2 v[14:15], v8, s[44:47], s29 offen sc1
    s_waitcnt vmcnt(0)
    v_mfma_f32_32x32x16_bf16 v[96:111], v[28:31], v[20:23], 0
    v_mfma_f32_32x32x8_bf16 v[96:111], v[14:15], v[26:27], v[96:111]
    s_nop 15
    v_max3_f32 v2, v2, v96, v97
    v_max3_f32 v2, v2, v98, v99
    v_max3_f32 v2, v2, v100, v101
    v_max3_f32 v2, v2, v102, v103
    v_max3_f32 v2, v2, v104, v105
    v_max3_f32 v2, v2, v106, v107
    v_max3_f32 v2, v2, v108, v109
    v_max3_f32 v2, v2, v110, v111
    s_add_u32 s29, s29, 82048
    s_cmp_lt_u32 s29, 5251072
    s_cbranch_scc1 L2_fb_max
    v_mov_b32 v4, v2
    s_nop 1
    v_permlane32_swap_b32 v4, v2
    s_nop 1
    v_max_f32 v2, v4, v2
    v_cvt_pk_bf16_f32 v4, -v2, -v2
    v_and_b32 v4, 0xffff0000, v4
    v_sub_f32 v2, -v2, v4
    v_cvt_pk_bf16_f32 v5, v2, v2
    v_and_b32 v5, 0xffff0000, v5
    v_sub_f32 v2, v2, v5
    v_cvt_pk_bf16_f32 v4, v4, v5
    v_cvt_pk_bf16_f32 v5, v2, 0
    v_cndmask_b32 v26, v26, v4, s[52:53]
    v_cndmask_b32 v27, v27, v5, s[52:53]
    v_mov_b32 v64, 0
    v_mov_b32 v65, 0
    v_mov_b32 v66, 0
    v_mov_b32 v67, 0
    v_mov_b32 v68, 0
    v_mov_b32 v69, 0
    v_mov_b32 v70, 0
    v_mov_b32 v71, 0
    v_mov_b32 v72, 0
    v_mov_b32 v73, 0
    v_mov_b32 v74, 0
    v_mov_b32 v75, 0
    v_mov_b32 v76, 0
    v_mov_b32 v77, 0
    v_mov_b32 v78, 0
    v_mov_b32 v79, 0
    s_mov_b32 s29, 0
L2_fb_pv:
    buffer_load_dwordx4 v[28:31], v7, s[44:47], s29 offen sc1
    buffer_load_dwordx2 v[14:15], v8, s[44:47], s29 offen sc1
    buffer_load_dwordx4 v[32:35], v11, s[44:47], s29 offen sc1
    buffer_load_dwordx4 v[40:43], v13, s[44:47], s29 offen sc1
    s_waitcnt vmcnt(0)
    v_mfma_f32_32x32x16_bf16 v[96:111], v[28:31], v[20:23], 0
    v_mfma_f32_32x32x8_bf16 v[96:111], v[14:15], v[26:27], v[96:111]
    s_nop 15
    v_exp_f32 v96, v96
    v_exp_f32 v97, v97
    v_exp_f32 v98, v98
    v_exp_f32 v99, v99
    v_exp_f32 v100, v100
    v_exp_f32 v101, v101
    v_exp_f32 v102, v102
    v_exp_f32 v103, v103
    v_exp_f32 v104, v104
    v_exp_f32 v105, v105
    v_exp_f32 v106, v106
    v_exp_f32 v107, v107
    v_exp_f32 v108, v108
    v_exp_f32 v109, v109
    v_exp_f32 v110, v110
    v_exp_f32 v111, v111
    s_nop 1
    v_smfmac_f32_32x32x32_bf16 v[64:79], v[32:35], v[96:103], v12
    v_smfmac_f32_32x32x32_bf16 v[64:79], v[40:43], v[104:111], v12
    s_add_u32 s29, s29, 82048
    s_cmp_lt_u32 s29, 5251072
    s_cbranch_scc1 L2_fb_pv
    s_nop 15
    v_mov_b32 v2, v72
    v_mov_b32 v3, v72
    s_nop 1
    v_permlane32_swap_b32 v2, v3
    s_nop 1
    v_rcp_f32 v2, v3
    s_nop 0
    v_pk_mul_f32 v[96:97], v[2:3], v[64:65] op_sel_hi:[0,1]
    v_pk_mul_f32 v[98:99], v[2:3], v[66:67] op_sel_hi:[0,1]
    v_pk_mul_f32 v[100:101], v[2:3], v[68:69] op_sel_hi:[0,1]
    v_pk_mul_f32 v[102:103], v[2:3], v[70:71] op_sel_hi:[0,1]
    v_pk_mul_f32 v[104:105], v[2:3], v[72:73] op_sel_hi:[0,1]
    v_pk_mul_f32 v[106:107], v[2:3], v[74:75] op_sel_hi:[0,1]
    v_cvt_pk_bf16_f32 v96, v96, v97
    v_cvt_pk_bf16_f32 v97, v98, v99
    v_cvt_pk_bf16_f32 v98, v100, v101
    v_cvt_pk_bf16_f32 v99, v102, v103
    v_cvt_pk_bf16_f32 v100, v104, v105
    v_cvt_pk_bf16_f32 v101, v106, v107
    v_permlane32_swap_b32 v96, v98
    v_permlane32_swap_b32 v97, v99
    buffer_store_dwordx4 v[96:99], v9, s[40:43], s59 offen sc1
    s_mov_b32 exec_hi, 0
    buffer_store_dwordx2 v[100:101], v6, s[40:43], s59 offen sc1
    s_mov_b64 exec, -1
    s_branch L2_stored
L2_service:
    s_setprio 2
    s_lshr_b32 s29, s25, 1
    s_lshl_b32 s29, s29, 7
    s_add_u32 s29, s29, 10536192
    s_add_u32 s30, s67, 10537216
    s_mov_b32 s31, 10537216
    v_mov_b32 v2, 1
    s_cmp_lg_u32 s52, 0
    s_barrier
    s_cbranch_scc1 L_polled_q
    s_mov_b64 exec, 1
    buffer_atomic_add v2, v106, s[40:43], s29 offen sc0 sc1
    s_waitcnt vmcnt(0)
    v_cmp_eq_u32 vcc, 31, v2
    s_cbranch_vccz L2_q_notlast
    s_mov_b64 exec, 0xff
    buffer_atomic_add v107, v106, s[40:43], s31 offen sc1
    s_mov_b64 exec, 1
L2_q_notlast:
    s_mov_b32 s60, 1048576
L_poll_q:
    buffer_load_dword v2, v106, s[40:43], s30 offen sc1
    s_sub_u32 s60, s60, 1
    s_cbranch_scc1 L_polled_q
    s_waitcnt vmcnt(0)
    v_cmp_gt_u32 vcc, 8, v2
    s_cbranch_vccnz L_poll_q
L_polled_q:
    s_mov_b64 exec, -1
    s_barrier
    s_mul_i32 s58, s53, 656384
    s_add_u32 m0, s54, s55
    s_add_u32 s53, s53, 1
    buffer_load_dwordx4 v100, s[44:47], s58 offen sc1 lds
    s_add_u32 m0, s54, s56
    s_and_b32 s53, s53, 7
    buffer_load_dwordx4 v101, s[44:47], s58 offen sc1 lds
    s_add_u32 m0, s54, s57
    s_add_u32 s54, s54, 23552
    s_waitcnt vmcnt(0)
    buffer_load_dwordx4 v102, s[44:47], s58 offen offset:0 sc1 lds
    buffer_load_dwordx4 v103, s[44:47], s58 offen offset:1024 sc1 lds
    buffer_load_dwordx4 v104, s[44:47], s58 offen offset:2048 sc1 lds
    buffer_load_dwordx4 v105, s[44:47], s58 offen offset:3072 sc1 lds
    s_cmp_eq_u32 s54, 70656
    s_cselect_b32 s54, 0, s54
    s_waitcnt vmcnt(4)
    s_barrier
    s_lshr_b32 s30, s3, 2
    s_and_b32 s29, s2, 7
    s_lshl3_add_u32 s30, s30, s29
    s_and_b32 s29, s3, 3
    s_lshl2_add_u32 s59, s30, s29
    s_cmp_lt_u32 s30, 27
    s_waitcnt vmcnt(0)
    s_barrier
    s_cbranch_scc1 L2_worker
    s_mul_i32 s58, s53, 656384
    s_add_u32 m0, s54, s55
    s_add_u32 s53, s53, 1
    buffer_load_dwordx4 v100, s[44:47], s58 offen sc1 lds
    s_add_u32 m0, s54, s56
    s_and_b32 s53, s53, 7
    buffer_load_dwordx4 v101, s[44:47], s58 offen sc1 lds
    s_add_u32 m0, s54, s57
    s_add_u32 s54, s54, 23552
    buffer_load_dwordx4 v102, s[44:47], s58 offen offset:0 sc1 lds
    buffer_load_dwordx4 v103, s[44:47], s58 offen offset:1024 sc1 lds
    buffer_load_dwordx4 v104, s[44:47], s58 offen offset:2048 sc1 lds
    buffer_load_dwordx4 v105, s[44:47], s58 offen offset:3072 sc1 lds
    s_cmp_eq_u32 s54, 70656
    s_cselect_b32 s54, 0, s54
    s_mov_b64 exec, 0xfffff
    global_load_dword v5, v140, s[20:21]
    global_load_dword v5, v140, s[22:23]
    global_load_dword v5, v141, s[18:19]
    s_mov_b64 exec, -1
    s_waitcnt vmcnt(3)
    s_barrier
    s_mul_i32 s58, s53, 656384
    s_add_u32 m0, s54, s55
    s_add_u32 s53, s53, 1
    buffer_load_dwordx4 v100, s[44:47], s58 offen sc1 lds
    s_add_u32 m0, s54, s56
    s_and_b32 s53, s53, 7
    buffer_load_dwordx4 v101, s[44:47], s58 offen sc1 lds
    s_add_u32 m0, s54, s57
    s_add_u32 s54, s54, 23552
    buffer_load_dwordx4 v102, s[44:47], s58 offen offset:0 sc1 lds
    buffer_load_dwordx4 v103, s[44:47], s58 offen offset:1024 sc1 lds
    buffer_load_dwordx4 v104, s[44:47], s58 offen offset:2048 sc1 lds
    buffer_load_dwordx4 v105, s[44:47], s58 offen offset:3072 sc1 lds
    s_cmp_eq_u32 s54, 70656
    s_cselect_b32 s54, 0, s54
    v_add_u32 v140, 69120, v140
    v_add_u32 v141, 2560, v141
    s_mov_b64 exec, 0xfffff
    global_load_dword v5, v140, s[20:21]
    global_load_dword v5, v140, s[22:23]
    global_load_dword v5, v141, s[18:19]
    s_mov_b64 exec, 0x1fff
    global_load_dword v5, v142, s[14:15]
    s_mov_b64 exec, -1
    s_mov_b64 exec, 0xffffffff
    buffer_load_dword v5, v158, s[40:43], 0 offen
    s_mov_b64 exec, -1
    s_waitcnt vmcnt(5)
    s_barrier
    s_mov_b32 s60, 4
L2_sv_loop:
    s_mul_i32 s58, s53, 656384
    s_add_u32 m0, s54, s55
    s_add_u32 s53, s53, 1
    buffer_load_dwordx4 v100, s[44:47], s58 offen sc1 lds
    s_add_u32 m0, s54, s56
    s_and_b32 s53, s53, 7
    buffer_load_dwordx4 v101, s[44:47], s58 offen sc1 lds
    s_add_u32 m0, s54, s57
    s_add_u32 s54, s54, 23552
    buffer_load_dwordx4 v102, s[44:47], s58 offen offset:0 sc1 lds
    buffer_load_dwordx4 v103, s[44:47], s58 offen offset:1024 sc1 lds
    buffer_load_dwordx4 v104, s[44:47], s58 offen offset:2048 sc1 lds
    buffer_load_dwordx4 v105, s[44:47], s58 offen offset:3072 sc1 lds
    s_cmp_eq_u32 s54, 70656
    s_cselect_b32 s54, 0, s54
    s_sub_u32 s60, s60, 1
    s_cmp_lg_u32 s60, 0
    s_waitcnt vmcnt(0)
    s_barrier
    s_cbranch_scc1 L2_sv_loop
    s_mul_i32 s58, s53, 656384
    s_add_u32 m0, s54, s55
    s_add_u32 s53, s53, 1
    buffer_load_dwordx4 v100, s[44:47], s58 offen sc1 lds
    s_add_u32 m0, s54, s56
    s_and_b32 s53, s53, 7
    buffer_load_dwordx4 v101, s[44:47], s58 offen sc1 lds
    s_add_u32 m0, s54, s57
    s_add_u32 s54, s54, 23552
    buffer_load_dwordx4 v102, s[44:47], s58 offen offset:0 sc1 lds
    buffer_load_dwordx4 v103, s[44:47], s58 offen offset:1024 sc1 lds
    buffer_load_dwordx4 v104, s[44:47], s58 offen offset:2048 sc1 lds
    buffer_load_dwordx4 v105, s[44:47], s58 offen offset:3072 sc1 lds
    s_cmp_eq_u32 s54, 70656
    s_cselect_b32 s54, 0, s54
    s_mov_b32 s36, s14
    s_mov_b32 s37, s15
    s_mov_b32 s38, 819200
    s_mov_b32 s39, 0x20000
    s_mul_i32 s61, s52, 20480
    s_add_u32 s61, s61, 70656
    s_mul_i32 s62, s52, 204800
    s_mov_b32 m0, s61
    s_add_u32 s61, s61, 1024
    buffer_load_dwordx4 v143, s[36:39], s62 offen lds
    s_add_u32 s62, s62, 10240
    s_mov_b32 m0, s61
    s_add_u32 s61, s61, 1024
    buffer_load_dwordx4 v143, s[36:39], s62 offen lds
    s_add_u32 s62, s62, 10240
    s_mov_b32 m0, s61
    s_add_u32 s61, s61, 1024
    buffer_load_dwordx4 v143, s[36:39], s62 offen lds
    s_add_u32 s62, s62, 10240
    s_mov_b32 m0, s61
    s_add_u32 s61, s61, 1024
    buffer_load_dwordx4 v143, s[36:39], s62 offen lds
    s_add_u32 s62, s62, 10240
    s_mov_b32 m0, s61
    s_add_u32 s61, s61, 1024
    buffer_load_dwordx4 v143, s[36:39], s62 offen lds
    s_add_u32 s62, s62, 10240
    s_mov_b32 m0, s61
    s_add_u32 s61, s61, 1024
    buffer_load_dwordx4 v143, s[36:39], s62 offen lds
    s_add_u32 s62, s62, 10240
    s_mov_b32 m0, s61
    s_add_u32 s61, s61, 1024
    buffer_load_dwordx4 v143, s[36:39], s62 offen lds
    s_add_u32 s62, s62, 10240
    s_mov_b32 m0, s61
    s_add_u32 s61, s61, 1024
    buffer_load_dwordx4 v143, s[36:39], s62 offen lds
    s_add_u32 s62, s62, 10240
    s_mov_b32 m0, s61
    s_add_u32 s61, s61, 1024
    buffer_load_dwordx4 v143, s[36:39], s62 offen lds
    s_add_u32 s62, s62, 10240
    s_mov_b32 m0, s61
    s_add_u32 s61, s61, 1024
    buffer_load_dwordx4 v143, s[36:39], s62 offen lds
    s_add_u32 s62, s62, 10240
    s_waitcnt vmcnt(10)
    s_barrier
    s_branch L2_sv_tail
L2_worker:
    s_mul_i32 s58, s53, 656384
    s_add_u32 m0, s54, s55
    s_add_u32 s53, s53, 1
    buffer_load_dwordx4 v100, s[44:47], s58 offen sc1 lds
    s_add_u32 m0, s54, s56
    s_and_b32 s53, s53, 7
    buffer_load_dwordx4 v101, s[44:47], s58 offen sc1 lds
    s_add_u32 m0, s54, s57
    s_add_u32 s54, s54, 23552
    buffer_load_dwordx4 v102, s[44:47], s58 offen offset:0 sc1 lds
    buffer_load_dwordx4 v103, s[44:47], s58 offen offset:1024 sc1 lds
    buffer_load_dwordx4 v104, s[44:47], s58 offen offset:2048 sc1 lds
    buffer_load_dwordx4 v105, s[44:47], s58 offen offset:3072 sc1 lds
    s_cmp_eq_u32 s54, 70656
    s_cselect_b32 s54, 0, s54
    s_mov_b32 s29, 10526720
    buffer_load_dword v19, v144, s[40:43], s29 offen sc1
    s_mov_b32 s32, s4
    s_mov_b32 s33, s5
    s_mov_b32 s34, 2621440
    s_mov_b32 s35, 0x20000
    s_waitcnt vmcnt(0)
    s_barrier
    s_mul_i32 s58, s53, 656384
    s_add_u32 m0, s54, s55
    s_add_u32 s53, s53, 1
    buffer_load_dwordx4 v100, s[44:47], s58 offen sc1 lds
    s_add_u32 m0, s54, s56
    s_and_b32 s53, s53, 7
    buffer_load_dwordx4 v101, s[44:47], s58 offen sc1 lds
    s_add_u32 m0, s54, s57
    s_add_u32 s54, s54, 23552
    buffer_load_dwordx4 v102, s[44:47], s58 offen offset:0 sc1 lds
    buffer_load_dwordx4 v103, s[44:47], s58 offen offset:1024 sc1 lds
    buffer_load_dwordx4 v104, s[44:47], s58 offen offset:2048 sc1 lds
    buffer_load_dwordx4 v105, s[44:47], s58 offen offset:3072 sc1 lds
    s_cmp_eq_u32 s54, 70656
    s_cselect_b32 s54, 0, s54
    s_mov_b32 s31, 1280
    v_mad_u32_u24 v21, v19, s31, v145
    v_lshlrev_b32 v23, 4, v19
    s_mul_i32 s29, s52, 320
    s_mov_b32 s30, 10493952
    s_mov_b32 exec_lo, 0x00ff00ff
    s_mov_b32 exec_hi, 0x00ff00ff
    buffer_load_dwordx4 v[28:31], v21, s[32:35], s29 offen offset:0
    buffer_load_dwordx4 v[32:35], v21, s[32:35], s29 offen offset:64
    buffer_load_dwordx4 v[36:39], v21, s[32:35], s29 offen offset:128
    buffer_load_dwordx4 v[40:43], v21, s[32:35], s29 offen offset:192
    buffer_load_dwordx4 v[44:47], v21, s[32:35], s29 offen offset:256
    s_not_b64 exec, exec
    buffer_load_dwordx4 v[28:31], v147, s[40:43], 0 offen sc1
    buffer_load_dwordx4 v[32:35], v147, s[40:43], 0 offen sc1
    buffer_load_dwordx4 v[36:39], v147, s[40:43], 0 offen sc1
    buffer_load_dwordx4 v[40:43], v147, s[40:43], 0 offen sc1
    buffer_load_dwordx4 v[44:47], v147, s[40:43], 0 offen sc1
    s_mov_b64 exec, -1
    buffer_load_dwordx2 v[24:25], v23, s[40:43], s30 offen sc1
    s_mov_b32 s32, s20
    s_mov_b32 s33, s21
    s_mov_b32 s34, 2211840
    s_mov_b32 s35, 0x20000
    s_mov_b32 s36, s22
    s_mov_b32 s37, s23
    s_mov_b32 s38, 2211840
    s_mov_b32 s39, 0x20000
    s_mov_b32 s48, s18
    s_mov_b32 s49, s19
    s_mov_b32 s50, 2211840
    s_mov_b32 s51, 0x20000
    s_mul_i32 s62, s52, 552960
    s_lshl_b32 s30, s59, 5
    s_add_u32 s62, s62, s30
    s_mul_i32 s61, s52, 5120
    s_mov_b64 exec, 0xffffffff
    buffer_load_dword v5, v158, s[40:43], 0 offen
    s_mov_b64 exec, -1
    s_waitcnt vmcnt(12)
    s_barrier
    s_mul_i32 s58, s53, 656384
    s_add_u32 m0, s54, s55
    s_add_u32 s53, s53, 1
    buffer_load_dwordx4 v100, s[44:47], s58 offen sc1 lds
    s_add_u32 m0, s54, s56
    s_and_b32 s53, s53, 7
    buffer_load_dwordx4 v101, s[44:47], s58 offen sc1 lds
    s_add_u32 m0, s54, s57
    s_add_u32 s54, s54, 23552
    buffer_load_dwordx4 v102, s[44:47], s58 offen offset:0 sc1 lds
    buffer_load_dwordx4 v103, s[44:47], s58 offen offset:1024 sc1 lds
    buffer_load_dwordx4 v104, s[44:47], s58 offen offset:2048 sc1 lds
    buffer_load_dwordx4 v105, s[44:47], s58 offen offset:3072 sc1 lds
    s_cmp_eq_u32 s54, 70656
    s_cselect_b32 s54, 0, s54
    s_add_u32 m0, s61, 70656
    s_add_u32 s30, s62, 0
    buffer_load_dwordx4 v148, s[32:35], s30 offen lds
    s_add_u32 m0, s61, 91136
    s_nop 0
    buffer_load_dwordx4 v148, s[36:39], s30 offen lds
    s_add_u32 m0, s61, 71680
    s_add_u32 s30, s62, 110592
    buffer_load_dwordx4 v148, s[32:35], s30 offen lds
    s_add_u32 m0, s61, 92160
    s_nop 0
    buffer_load_dwordx4 v148, s[36:39], s30 offen lds
    s_add_u32 m0, s61, 72704
    s_add_u32 s30, s62, 221184
    buffer_load_dwordx4 v148, s[32:35], s30 offen lds
    s_add_u32 m0, s61, 93184
    s_nop 0
    buffer_load_dwordx4 v148, s[36:39], s30 offen lds
    s_waitcnt vmcnt(6)
    s_barrier
    s_mul_i32 s58, s53, 656384
    s_add_u32 m0, s54, s55
    s_add_u32 s53, s53, 1
    buffer_load_dwordx4 v100, s[44:47], s58 offen sc1 lds
    s_add_u32 m0, s54, s56
    s_and_b32 s53, s53, 7
    buffer_load_dwordx4 v101, s[44:47], s58 offen sc1 lds
    s_add_u32 m0, s54, s57
    s_add_u32 s54, s54, 23552
    buffer_load_dwordx4 v102, s[44:47], s58 offen offset:0 sc1 lds
    buffer_load_dwordx4 v103, s[44:47], s58 offen offset:1024 sc1 lds
    buffer_load_dwordx4 v104, s[44:47], s58 offen offset:2048 sc1 lds
    buffer_load_dwordx4 v105, s[44:47], s58 offen offset:3072 sc1 lds
    s_cmp_eq_u32 s54, 70656
    s_cselect_b32 s54, 0, s54
    s_add_u32 m0, s61, 73728
    s_add_u32 s30, s62, 331776
    buffer_load_dwordx4 v148, s[32:35], s30 offen lds
    s_add_u32 m0, s61, 94208
    s_nop 0
    buffer_load_dwordx4 v148, s[36:39], s30 offen lds
    s_add_u32 m0, s61, 74752
    s_add_u32 s30, s62, 442368
    buffer_load_dwordx4 v148, s[32:35], s30 offen lds
    s_add_u32 m0, s61, 95232
    s_nop 0
    buffer_load_dwordx4 v148, s[36:39], s30 offen lds
    s_mul_i32 s29, s59, 20480
    s_mul_i32 s31, s52, 5
    s_add_u32 m0, s61, 111616
    s_and_b32 s30, s31, 3
    s_mul_i32 s30, s30, 5120
    s_lshr_b32 s58, s31, 2
    s_lshl_b32 s58, s58, 8
    s_add_u32 s30, s30, s58
    s_add_u32 s30, s30, s29
    buffer_load_dwordx4 v149, s[48:51], s30 offen lds
    s_add_u32 s31, s31, 1
    s_add_u32 m0, s61, 112640
    s_and_b32 s30, s31, 3
    s_mul_i32 s30, s30, 5120
    s_lshr_b32 s58, s31, 2
    s_lshl_b32 s58, s58, 8
    s_add_u32 s30, s30, s58
    s_add_u32 s30, s30, s29
    buffer_load_dwordx4 v150, s[48:51], s30 offen lds
    s_add_u32 s31, s31, 1
    s_add_u32 m0, s61, 113664
    s_and_b32 s30, s31, 3
    s_mul_i32 s30, s30, 5120
    s_lshr_b32 s58, s31, 2
    s_lshl_b32 s58, s58, 8
    s_add_u32 s30, s30, s58
    s_add_u32 s30, s30, s29
    buffer_load_dwordx4 v149, s[48:51], s30 offen lds
    s_add_u32 s31, s31, 1
    s_add_u32 m0, s61, 114688
    s_and_b32 s30, s31, 3
    s_mul_i32 s30, s30, 5120
    s_lshr_b32 s58, s31, 2
    s_lshl_b32 s58, s58, 8
    s_add_u32 s30, s30, s58
    s_add_u32 s30, s30, s29
    buffer_load_dwordx4 v150, s[48:51], s30 offen lds
    s_add_u32 s31, s31, 1
    s_add_u32 m0, s61, 115712
    s_and_b32 s30, s31, 3
    s_mul_i32 s30, s30, 5120
    s_lshr_b32 s58, s31, 2
    s_lshl_b32 s58, s58, 8
    s_add_u32 s30, s30, s58
    s_add_u32 s30, s30, s29
    buffer_load_dwordx4 v149, s[48:51], s30 offen lds
    s_waitcnt vmcnt(9)
    s_barrier
    s_mul_i32 s58, s53, 656384
    s_add_u32 m0, s54, s55
    s_add_u32 s53, s53, 1
    buffer_load_dwordx4 v100, s[44:47], s58 offen sc1 lds
    s_add_u32 m0, s54, s56
    s_and_b32 s53, s53, 7
    buffer_load_dwordx4 v101, s[44:47], s58 offen sc1 lds
    s_add_u32 m0, s54, s57
    s_add_u32 s54, s54, 23552
    buffer_load_dwordx4 v102, s[44:47], s58 offen offset:0 sc1 lds
    buffer_load_dwordx4 v103, s[44:47], s58 offen offset:1024 sc1 lds
    buffer_load_dwordx4 v104, s[44:47], s58 offen offset:2048 sc1 lds
    buffer_load_dwordx4 v105, s[44:47], s58 offen offset:3072 sc1 lds
    s_cmp_eq_u32 s54, 70656
    s_cselect_b32 s54, 0, s54
    s_waitcnt vmcnt(11)
    ds_read_b64_tr_b16 v[48:49], v151 offset:0
    ds_read_b64_tr_b16 v[50:51], v151 offset:256
    ds_read_b64_tr_b16 v[52:53], v151 offset:20480
    ds_read_b64_tr_b16 v[54:55], v151 offset:20736
    ds_read_b64_tr_b16 v[56:57], v151 offset:1024
    ds_read_b64_tr_b16 v[58:59], v151 offset:1280
    ds_read_b64_tr_b16 v[60:61], v151 offset:21504
    ds_read_b64_tr_b16 v[62:63], v151 offset:21760
    ds_read_b64_tr_b16 v[64:65], v151 offset:2048
    ds_read_b64_tr_b16 v[66:67], v151 offset:2304
    ds_read_b64_tr_b16 v[68:69], v151 offset:22528
    ds_read_b64_tr_b16 v[70:71], v151 offset:22784
    ds_read_b64_tr_b16 v[72:73], v151 offset:3072
    ds_read_b64_tr_b16 v[74:75], v151 offset:3328
    ds_read_b64_tr_b16 v[76:77], v151 offset:23552
    ds_read_b64_tr_b16 v[78:79], v151 offset:23808
    ds_read_b64_tr_b16 v[80:81], v151 offset:4096
    ds_read_b64_tr_b16 v[82:83], v151 offset:4352
    ds_read_b64_tr_b16 v[84:85], v151 offset:24576
    ds_read_b64_tr_b16 v[86:87], v151 offset:24832
    s_setprio 0
    s_waitcnt lgkmcnt(0)
    v_mfma_f32_16x16x32_bf16 v[88:91], v[48:51], v[28:31], 0
    v_mfma_f32_16x16x32_bf16 v[92:95], v[52:55], v[28:31], 0
    v_mfma_f32_16x16x32_bf16 v[88:91], v[56:59], v[32:35], v[88:91]
    v_mfma_f32_16x16x32_bf16 v[92:95], v[60:63], v[32:35], v[92:95]
    v_mfma_f32_16x16x32_bf16 v[88:91], v[64:67], v[36:39], v[88:91]
    v_mfma_f32_16x16x32_bf16 v[92:95], v[68:71], v[36:39], v[92:95]
    v_mfma_f32_16x16x32_bf16 v[88:91], v[72:75], v[40:43], v[88:91]
    v_mfma_f32_16x16x32_bf16 v[92:95], v[76:79], v[40:43], v[92:95]
    v_mfma_f32_16x16x32_bf16 v[88:91], v[80:83], v[44:47], v[88:91]
    v_mfma_f32_16x16x32_bf16 v[92:95], v[84:87], v[44:47], v[92:95]
    s_setprio 2
    s_nop 7
    ds_write2st64_b32 v154, v88, v89 offset0:0 offset1:1
    ds_write2st64_b32 v154, v90, v91 offset0:2 offset1:3
    ds_write2st64_b32 v154, v92, v93 offset0:4 offset1:5
    ds_write2st64_b32 v154, v94, v95 offset0:6 offset1:7
    s_waitcnt vmcnt(0) lgkmcnt(0)
    s_barrier
    s_mul_i32 s58, s53, 656384
    s_add_u32 m0, s54, s55
    s_add_u32 s53, s53, 1
    buffer_load_dwordx4 v100, s[44:47], s58 offen sc1 lds
    s_add_u32 m0, s54, s56
    s_and_b32 s53, s53, 7
    buffer_load_dwordx4 v101, s[44:47], s58 offen sc1 lds
    s_add_u32 m0, s54, s57
    s_add_u32 s54, s54, 23552
    buffer_load_dwordx4 v102, s[44:47], s58 offen offset:0 sc1 lds
    buffer_load_dwordx4 v103, s[44:47], s58 offen offset:1024 sc1 lds
    buffer_load_dwordx4 v104, s[44:47], s58 offen offset:2048 sc1 lds
    buffer_load_dwordx4 v105, s[44:47], s58 offen offset:3072 sc1 lds
    s_cmp_eq_u32 s54, 70656
    s_cselect_b32 s54, 0, s54
    ds_read2st64_b32 v[48:49], v155 offset0:0 offset1:4
    ds_read2st64_b32 v[50:51], v155 offset0:8 offset1:12
    ds_read2st64_b32 v[52:53], v155 offset0:16 offset1:20
    ds_read2st64_b32 v[54:55], v155 offset0:24 offset1:28
    ds_read_b64_tr_b16 v[28:29], v152 offset:0
    ds_read_b64_tr_b16 v[30:31], v153 offset:0
    ds_read_b64_tr_b16 v[32:33], v152 offset:4096
    ds_read_b64_tr_b16 v[34:35], v153 offset:4096
    ds_read_b64_tr_b16 v[36:37], v152 offset:8192
    ds_read_b64_tr_b16 v[38:39], v153 offset:8192
    ds_read_b64_tr_b16 v[40:41], v152 offset:12288
    ds_read_b64_tr_b16 v[42:43], v153 offset:12288
    ds_read_b64_tr_b16 v[44:45], v152 offset:16384
    ds_read_b64_tr_b16 v[46:47], v153 offset:16384
    s_setprio 0
    s_waitcnt lgkmcnt(10)
    v_add_f32 v48, v48, v50
    v_add_f32 v52, v52, v54
    v_add_f32 v49, v49, v51
    v_add_f32 v53, v53, v55
    v_add_f32 v88, v48, v52
    v_add_f32 v89, v49, v53
    s_nop 1
    v_mul_f32_dpp v48, v88, v24 row_newbcast:8 row_mask:0xf bank_mask:0xf
    v_mul_f32_dpp v49, v89, v24 row_newbcast:8 row_mask:0xf bank_mask:0xf
    v_sub_f32 v88, v88, v48
    v_sub_f32 v89, v89, v49
    v_mul_f32 v88, v25, v88
    v_mul_f32 v89, v25, v89
    v_cvt_pk_bf16_f32 v89, v88, v89
    v_lshlrev_b32 v88, 16, v89
    v_mul_f32 v48, 0xbfb8aa3b, v88
    v_exp_f32 v48, v48
    v_and_b32 v89, 0xffff0000, v89
    v_add_f32 v48, 1.0, v48
    v_rcp_f32 v48, v48
    s_nop 0
    v_mul_f32 v88, v88, v48
    v_cvt_pk_bf16_f32 v88, v88, v88
    v_and_b32 v88, 0xffff0000, v88
    v_mul_f32 v88, v88, v89
    v_cvt_pk_bf16_f32 v88, v88, v88
    s_setprio 2
    ds_write_b16 v157, v88
    s_waitcnt vmcnt(0) lgkmcnt(0)
    s_barrier
    s_mul_i32 s58, s53, 656384
    s_add_u32 m0, s54, s55
    s_add_u32 s53, s53, 1
    buffer_load_dwordx4 v100, s[44:47], s58 offen sc1 lds
    s_add_u32 m0, s54, s56
    s_and_b32 s53, s53, 7
    buffer_load_dwordx4 v101, s[44:47], s58 offen sc1 lds
    s_add_u32 m0, s54, s57
    s_add_u32 s54, s54, 23552
    buffer_load_dwordx4 v102, s[44:47], s58 offen offset:0 sc1 lds
    buffer_load_dwordx4 v103, s[44:47], s58 offen offset:1024 sc1 lds
    buffer_load_dwordx4 v104, s[44:47], s58 offen offset:2048 sc1 lds
    buffer_load_dwordx4 v105, s[44:47], s58 offen offset:3072 sc1 lds
    s_cmp_eq_u32 s54, 70656
    s_cselect_b32 s54, 0, s54
    ds_read_b64 v[96:97], v156
    s_mul_i32 s31, s59, 20480
    s_lshl_b32 s30, s52, 7
    s_add_u32 s31, s31, s30
    s_add_u32 s31, s31, 10691840
    s_waitcnt lgkmcnt(0)
    v_mfma_f32_16x16x16_bf16 v[48:51], v[28:29], v[96:97], 0
    v_mfma_f32_16x16x16_bf16 v[52:55], v[30:31], v[96:97], 0
    v_mfma_f32_16x16x16_bf16 v[56:59], v[32:33], v[96:97], 0
    v_mfma_f32_16x16x16_bf16 v[60:63], v[34:35], v[96:97], 0
    v_mfma_f32_16x16x16_bf16 v[64:67], v[36:37], v[96:97], 0
    v_mfma_f32_16x16x16_bf16 v[68:71], v[38:39], v[96:97], 0
    v_mfma_f32_16x16x16_bf16 v[72:75], v[40:41], v[96:97], 0
    v_mfma_f32_16x16x16_bf16 v[76:79], v[42:43], v[96:97], 0
    v_mfma_f32_16x16x16_bf16 v[80:83], v[44:45], v[96:97], 0
    v_mfma_f32_16x16x16_bf16 v[84:87], v[46:47], v[96:97], 0
    s_mov_b32 s36, s14
    s_mov_b32 s37, s15
    s_mov_b32 s38, 819200
    s_mov_b32 s39, 0x20000
    s_mul_i32 s61, s52, 20480
    s_add_u32 s61, s61, 70656
    s_mul_i32 s62, s52, 204800
    s_mov_b32 exec_lo, 0x00ff00ff
    s_mov_b32 exec_hi, 0x00ff00ff
    buffer_store_dwordx4 v[48:51], v146, s[40:43], s31 offen offset:0 sc1
    buffer_store_dwordx4 v[52:55], v146, s[40:43], s31 offen offset:64 sc1
    buffer_store_dwordx4 v[56:59], v146, s[40:43], s31 offen offset:512 sc1
    buffer_store_dwordx4 v[60:63], v146, s[40:43], s31 offen offset:576 sc1
    buffer_store_dwordx4 v[64:67], v146, s[40:43], s31 offen offset:1024 sc1
    buffer_store_dwordx4 v[68:71], v146, s[40:43], s31 offen offset:1088 sc1
    buffer_store_dwordx4 v[72:75], v146, s[40:43], s31 offen offset:1536 sc1
    buffer_store_dwordx4 v[76:79], v146, s[40:43], s31 offen offset:1600 sc1
    buffer_store_dwordx4 v[80:83], v146, s[40:43], s31 offen offset:2048 sc1
    buffer_store_dwordx4 v[84:87], v146, s[40:43], s31 offen offset:2112 sc1
    s_mov_b64 exec, -1
    s_mov_b32 m0, s61
    s_add_u32 s61, s61, 1024
    buffer_load_dwordx4 v143, s[36:39], s62 offen lds
    s_add_u32 s62, s62, 10240
    s_mov_b32 m0, s61
    s_add_u32 s61, s61, 1024
    buffer_load_dwordx4 v143, s[36:39], s62 offen lds
    s_add_u32 s62, s62, 10240
    s_mov_b32 m0, s61
    s_add_u32 s61, s61, 1024
    buffer_load_dwordx4 v143, s[36:39], s62 offen lds
    s_add_u32 s62, s62, 10240
    s_mov_b32 m0, s61
    s_add_u32 s61, s61, 1024
    buffer_load_dwordx4 v143, s[36:39], s62 offen lds
    s_add_u32 s62, s62, 10240
    s_mov_b32 m0, s61
    s_add_u32 s61, s61, 1024
    buffer_load_dwordx4 v143, s[36:39], s62 offen lds
    s_add_u32 s62, s62, 10240
    s_mov_b32 m0, s61
    s_add_u32 s61, s61, 1024
    buffer_load_dwordx4 v143, s[36:39], s62 offen lds
    s_add_u32 s62, s62, 10240
    s_mov_b32 m0, s61
    s_add_u32 s61, s61, 1024
    buffer_load_dwordx4 v143, s[36:39], s62 offen lds
    s_add_u32 s62, s62, 10240
    s_mov_b32 m0, s61
    s_add_u32 s61, s61, 1024
    buffer_load_dwordx4 v143, s[36:39], s62 offen lds
    s_add_u32 s62, s62, 10240
    s_mov_b32 m0, s61
    s_add_u32 s61, s61, 1024
    buffer_load_dwordx4 v143, s[36:39], s62 offen lds
    s_add_u32 s62, s62, 10240
    s_mov_b32 m0, s61
    s_add_u32 s61, s61, 1024
    buffer_load_dwordx4 v143, s[36:39], s62 offen lds
    s_add_u32 s62, s62, 10240
    s_cmp_lg_u32 s52, 0
    s_waitcnt vmcnt(10)
    s_barrier
    s_cbranch_scc1 L2_sv_tail
    s_mov_b32 s29, 10535168
    s_mov_b64 exec, 0xff
    buffer_atomic_add v107, v106, s[40:43], s29 offen sc1
    s_mov_b64 exec, -1
L2_sv_tail:
    s_mov_b32 s29, 10526720
    buffer_load_dword v3, v144, s[40:43], s29 offen sc1
    s_cmp_eq_u32 s52, 1
    s_cbranch_scc1 L3_w9
    s_mov_b32 m0, s61
    s_add_u32 s61, s61, 1024
    buffer_load_dwordx4 v143, s[36:39], s62 offen lds
    s_add_u32 s62, s62, 10240
    s_mov_b32 m0, s61
    s_add_u32 s61, s61, 1024
    buffer_load_dwordx4 v143, s[36:39], s62 offen lds
    s_add_u32 s62, s62, 10240
    s_mov_b32 m0, s61
    s_add_u32 s61, s61, 1024
    buffer_load_dwordx4 v143, s[36:39], s62 offen lds
    s_add_u32 s62, s62, 10240
    s_mov_b32 m0, s61
    s_add_u32 s61, s61, 1024
    buffer_load_dwordx4 v143, s[36:39], s62 offen lds
    s_add_u32 s62, s62, 10240
    s_mov_b32 m0, s61
    s_add_u32 s61, s61, 1024
    buffer_load_dwordx4 v143, s[36:39], s62 offen lds
    s_add_u32 s62, s62, 10240
    s_mov_b32 m0, s61
    s_add_u32 s61, s61, 1024
    buffer_load_dwordx4 v143, s[36:39], s62 offen lds
    s_add_u32 s62, s62, 10240
    s_mov_b32 m0, s61
    s_add_u32 s61, s61, 1024
    buffer_load_dwordx4 v143, s[36:39], s62 offen lds
    s_add_u32 s62, s62, 10240
    s_mov_b32 m0, s61
    s_add_u32 s61, s61, 1024
    buffer_load_dwordx4 v143, s[36:39], s62 offen lds
    s_add_u32 s62, s62, 10240
    s_mov_b32 m0, s61
    s_add_u32 s61, s61, 1024
    buffer_load_dwordx4 v143, s[36:39], s62 offen lds
    s_add_u32 s62, s62, 10240
    s_mov_b32 m0, s61
    s_add_u32 s61, s61, 1024
    buffer_load_dwordx4 v143, s[36:39], s62 offen lds
    s_add_u32 s62, s62, 10240
    s_lshl_b32 s29, s28, 10
    s_add_u32 s29, s29, 10526976
    s_and_b32 s30, s2, 7
    s_lshl_b32 s30, s30, 10
    s_add_u32 s30, s30, 10526976
    s_barrier
    s_barrier
    s_cmp_lg_u32 s52, 0
    s_barrier
    s_cbranch_scc1 L3_sv_end
    s_mov_b64 exec, 1
    v_mov_b32 v2, 1
    s_sub_u32 s31, s29, 0
    buffer_atomic_add v2, v106, s[40:43], s29 offen offset:128 sc0 sc1
    s_waitcnt vmcnt(0)
    v_cmp_eq_u32 vcc, 31, v2
    s_cbranch_vccz L3_o_notlast
    buffer_store_dword v107, v106, s[40:43], s29 offen sc1
L3_o_notlast:
    s_cmp_ge_u32 s3, 30
    s_cbranch_scc1 L3_sv_end
    s_mov_b64 exec, 1
    s_mov_b32 s60, 1048576
L_poll_o:
    buffer_load_dword v2, v106, s[40:43], s30 offen sc1
    s_sub_u32 s60, s60, 1
    s_cbranch_scc1 L_polled_o
    s_waitcnt vmcnt(0)
    v_cmp_gt_u32 vcc, 1, v2
    s_cbranch_vccnz L_poll_o
L_polled_o:
    s_waitcnt vmcnt(0)
    s_barrier
    s_endpgm
L3_sv_end:
    s_waitcnt vmcnt(0)
    s_barrier
    s_endpgm
L3_w9:
    s_waitcnt vmcnt(0)
    v_readlane_b32 s4, v3, 0
    v_readlane_b32 s5, v3, 1
    v_readlane_b32 s6, v3, 2
    v_readlane_b32 s7, v3, 3
    v_readlane_b32 s8, v3, 4
    v_readlane_b32 s9, v3, 5
    v_readlane_b32 s10, v3, 6
    v_readlane_b32 s11, v3, 7
    s_mov_b32 s66, 0
    s_sub_u32 s29, s4, s63
    s_cmp_lt_u32 s29, s65
    s_cselect_b32 s29, 1, 0
    s_or_b32 s66, s66, s29
    s_sub_u32 s29, s5, s63
    s_cmp_lt_u32 s29, s65
    s_cselect_b32 s29, 2, 0
    s_or_b32 s66, s66, s29
    s_sub_u32 s29, s6, s63
    s_cmp_lt_u32 s29, s65
    s_cselect_b32 s29, 4, 0
    s_or_b32 s66, s66, s29
    s_sub_u32 s29, s7, s63
    s_cmp_lt_u32 s29, s65
    s_cselect_b32 s29, 8, 0
    s_or_b32 s66, s66, s29
    s_sub_u32 s29, s8, s63
    s_cmp_lt_u32 s29, s65
    s_cselect_b32 s29, 16, 0
    s_or_b32 s66, s66, s29
    s_sub_u32 s29, s9, s63
    s_cmp_lt_u32 s29, s65
    s_cselect_b32 s29, 32, 0
    s_or_b32 s66, s66, s29
    s_sub_u32 s29, s10, s63
    s_cmp_lt_u32 s29, s65
    s_cselect_b32 s29, 64, 0
    s_or_b32 s66, s66, s29
    s_sub_u32 s29, s11, s63
    s_cmp_lt_u32 s29, s65
    s_cselect_b32 s29, 128, 0
    s_or_b32 s66, s66, s29
    s_cmp_ge_u32 s3, 30
    s_cselect_b32 s66, 0, s66
    s_cmp_lg_u32 s66, 0
    s_cbranch_scc1 L3_w9_go
    s_mov_b32 m0, s61
    s_add_u32 s61, s61, 1024
    buffer_load_dwordx4 v143, s[36:39], s62 offen lds
    s_add_u32 s62, s62, 10240
    s_mov_b32 m0, s61
    s_add_u32 s61, s61, 1024
    buffer_load_dwordx4 v143, s[36:39], s62 offen lds
    s_add_u32 s62, s62, 10240
    s_mov_b32 m0, s61
    s_add_u32 s61, s61, 1024
    buffer_load_dwordx4 v143, s[36:39], s62 offen lds
    s_add_u32 s62, s62, 10240
    s_mov_b32 m0, s61
    s_add_u32 s61, s61, 1024
    buffer_load_dwordx4 v143, s[36:39], s62 offen lds
    s_add_u32 s62, s62, 10240
    s_mov_b32 m0, s61
    s_add_u32 s61, s61, 1024
    buffer_load_dwordx4 v143, s[36:39], s62 offen lds
    s_add_u32 s62, s62, 10240
    s_mov_b32 m0, s61
    s_add_u32 s61, s61, 1024
    buffer_load_dwordx4 v143, s[36:39], s62 offen lds
    s_add_u32 s62, s62, 10240
    s_mov_b32 m0, s61
    s_add_u32 s61, s61, 1024
    buffer_load_dwordx4 v143, s[36:39], s62 offen lds
    s_add_u32 s62, s62, 10240
    s_mov_b32 m0, s61
    s_add_u32 s61, s61, 1024
    buffer_load_dwordx4 v143, s[36:39], s62 offen lds
    s_add_u32 s62, s62, 10240
    s_mov_b32 m0, s61
    s_add_u32 s61, s61, 1024
    buffer_load_dwordx4 v143, s[36:39], s62 offen lds
    s_add_u32 s62, s62, 10240
    s_mov_b32 m0, s61
    s_add_u32 s61, s61, 1024
    buffer_load_dwordx4 v143, s[36:39], s62 offen lds
    s_add_u32 s62, s62, 10240
    s_barrier
    s_barrier
    s_barrier
    s_branch L3_sv_end
L3_w9_go:
    s_mov_b32 m0, s61
    s_add_u32 s61, s61, 1024
    buffer_load_dwordx4 v143, s[36:39], s62 offen lds
    s_add_u32 s62, s62, 10240
    s_mov_b32 m0, s61
    s_add_u32 s61, s61, 1024
    buffer_load_dwordx4 v143, s[36:39], s62 offen lds
    s_add_u32 s62, s62, 10240
    s_mov_b32 m0, s61
    s_add_u32 s61, s61, 1024
    buffer_load_dwordx4 v143, s[36:39], s62 offen lds
    s_add_u32 s62, s62, 10240
    s_mov_b32 m0, s61
    s_add_u32 s61, s61, 1024
    buffer_load_dwordx4 v143, s[36:39], s62 offen lds
    s_add_u32 s62, s62, 10240
    s_mov_b32 m0, s61
    s_add_u32 s61, s61, 1024
    buffer_load_dwordx4 v143, s[36:39], s62 offen lds
    s_add_u32 s62, s62, 10240
    s_mov_b32 m0, s61
    s_add_u32 s61, s61, 1024
    buffer_load_dwordx4 v143, s[36:39], s62 offen lds
    s_add_u32 s62, s62, 10240
    s_mov_b32 m0, s61
    s_add_u32 s61, s61, 1024
    buffer_load_dwordx4 v143, s[36:39], s62 offen lds
    s_add_u32 s62, s62, 10240
    s_mov_b32 m0, s61
    s_add_u32 s61, s61, 1024
    buffer_load_dwordx4 v143, s[36:39], s62 offen lds
    s_add_u32 s62, s62, 10240
    s_mov_b32 m0, s61
    s_add_u32 s61, s61, 1024
    buffer_load_dwordx4 v143, s[36:39], s62 offen lds
    s_add_u32 s62, s62, 10240
    s_mov_b32 m0, s61
    s_add_u32 s61, s61, 1024
    buffer_load_dwordx4 v143, s[36:39], s62 offen lds
    s_add_u32 s62, s62, 10240
    s_add_u32 s62, s67, 10535168
    v_mov_b32 v16, 0
    v_lshrrev_b32 v2, 4, v1
    v_mul_u32_u24 v2, 20480, v2
    v_and_b32 v3, 15, v1
    v_lshlrev_b32 v3, 4, v3
    v_add_u32 v2, v2, v3
    v_add_u32 v3, 153088, v3
    v_mov_b32 v20, 0
    v_mov_b32 v21, 0
    v_mov_b32 v22, 0
    v_mov_b32 v23, 0
    ds_write_b128 v3, v[20:23] offset:2048
    s_mov_b32 s61, 3
    buffer_load_dword v17, v16, s[40:43], s62 offen sc1
    s_waitcnt vmcnt(0)
    v_cmp_gt_u32 vcc, 108, v17
    s_cbranch_vccz L_polled_y
    buffer_load_dword v17, v16, s[40:43], s62 offen sc1
    s_waitcnt vmcnt(0)
    v_cmp_gt_u32 vcc, 108, v17
    s_cbranch_vccz L_polled_y
    s_barrier
    s_barrier
    s_barrier
    s_mov_b32 s61, 0
    s_mov_b32 s60, 1048576
L_poll_y:
    buffer_load_dword v17, v16, s[40:43], s62 offen sc1
    s_sub_u32 s60, s60, 1
    s_cbranch_scc1 L_polled_y
    s_waitcnt vmcnt(0)
    v_cmp_gt_u32 vcc, 108, v17
    s_cbranch_vccnz L_poll_y
L_polled_y:
L3_w9_tok:
    s_ff1_i32_b32 s58, s66
    s_bitset0_b32 s66, s58
    s_mov_b32 m0, s58
    s_mul_i32 s29, s58, 2560
    s_movrels_b32 s31, s4
    s_lshl_b32 s30, s64, 8
    s_add_u32 s29, s29, s30
    s_add_u32 s29, s29, 10691840
    s_lshl_b32 s31, s31, 4
    s_add_u32 s31, s31, 10493960
    buffer_load_dword v5, v16, s[40:43], s31 offen sc1
    buffer_load_dwordx4 v[28:31], v2, s[40:43], s29 offen sc1
    s_add_u32 s29, s29, 81920
    buffer_load_dwordx4 v[32:35], v2, s[40:43], s29 offen sc1
    s_add_u32 s29, s29, 81920
    buffer_load_dwordx4 v[36:39], v2, s[40:43], s29 offen sc1
    s_add_u32 s29, s29, 81920
    buffer_load_dwordx4 v[40:43], v2, s[40:43], s29 offen sc1
    s_add_u32 s29, s29, 81920
    buffer_load_dwordx4 v[44:47], v2, s[40:43], s29 offen sc1
    s_add_u32 s29, s29, 81920
    buffer_load_dwordx4 v[48:51], v2, s[40:43], s29 offen sc1
    s_add_u32 s29, s29, 81920
    buffer_load_dwordx4 v[52:55], v2, s[40:43], s29 offen sc1
    s_add_u32 s29, s29, 81920
    buffer_load_dwordx4 v[56:59], v2, s[40:43], s29 offen sc1
    s_add_u32 s29, s29, 81920
    buffer_load_dwordx4 v[60:63], v2, s[40:43], s29 offen sc1
    s_add_u32 s29, s29, 81920
    buffer_load_dwordx4 v[64:67], v2, s[40:43], s29 offen sc1
    s_add_u32 s29, s29, 81920
    buffer_load_dwordx4 v[68:71], v2, s[40:43], s29 offen sc1
    s_add_u32 s29, s29, 81920
    buffer_load_dwordx4 v[72:75], v2, s[40:43], s29 offen sc1
    s_add_u32 s29, s29, 81920
    buffer_load_dwordx4 v[76:79], v2, s[40:43], s29 offen sc1
    s_add_u32 s29, s29, 81920
    buffer_load_dwordx4 v[80:83], v2, s[40:43], s29 offen sc1
    s_add_u32 s29, s29, 81920
    buffer_load_dwordx4 v[84:87], v2, s[40:43], s29 offen sc1
    s_add_u32 s29, s29, 81920
    buffer_load_dwordx4 v[88:91], v2, s[40:43], s29 offen sc1
    s_add_u32 s29, s29, 81920
    buffer_load_dwordx4 v[92:95], v2, s[40:43], s29 offen sc1
    s_add_u32 s29, s29, 81920
    buffer_load_dwordx4 v[96:99], v2, s[40:43], s29 offen sc1
    s_add_u32 s29, s29, 81920
    buffer_load_dwordx4 v[100:103], v2, s[40:43], s29 offen sc1
    s_add_u32 s29, s29, 81920
    buffer_load_dwordx4 v[104:107], v2, s[40:43], s29 offen sc1
    s_add_u32 s29, s29, 81920
    buffer_load_dwordx4 v[108:111], v2, s[40:43], s29 offen sc1
    s_add_u32 s29, s29, 81920
    buffer_load_dwordx4 v[112:115], v2, s[40:43], s29 offen sc1
    s_add_u32 s29, s29, 81920
    buffer_load_dwordx4 v[116:119], v2, s[40:43], s29 offen sc1
    s_add_u32 s29, s29, 81920
    buffer_load_dwordx4 v[120:123], v2, s[40:43], s29 offen sc1
    s_add_u32 s29, s29, 81920
    buffer_load_dwordx4 v[124:127], v2, s[40:43], s29 offen sc1
    s_add_u32 s29, s29, 81920
    buffer_load_dwordx4 v[128:131], v2, s[40:43], s29 offen sc1
    s_add_u32 s29, s29, 81920
    buffer_load_dwordx4 v[132:135], v2, s[40:43], s29 offen sc1
    s_add_u32 s29, s29, 81920
    s_cmp_eq_u32 s61, 0
    s_cbranch_scc1 L3_w9_nb
    s_barrier
    s_barrier
    s_barrier
    s_mov_b32 s61, 0
L3_w9_nb:
    s_waitcnt vmcnt(27)
    v_cvt_pk_bf16_f32 v5, v5, v5
    v_and_b32 v5, 0xffff0000, v5
    v_mul_f32 v5, 0xbfb8aa3b, v5
    v_exp_f32 v5, v5
    s_nop 0
    v_add_f32 v5, 1.0, v5
    v_rcp_f32 v5, v5
    s_nop 0
    v_cvt_pk_bf16_f32 v5, v5, v5
    v_and_b32 v5, 0xffff0000, v5
    s_waitcnt vmcnt(22)
    v_pk_add_f32 v[28:29], v[28:29], v[32:33]
    v_pk_add_f32 v[30:31], v[30:31], v[34:35]
    v_pk_add_f32 v[28:29], v[28:29], v[36:37]
    v_pk_add_f32 v[30:31], v[30:31], v[38:39]
    v_pk_add_f32 v[28:29], v[28:29], v[40:41]
    v_pk_add_f32 v[30:31], v[30:31], v[42:43]
    v_pk_add_f32 v[28:29], v[28:29], v[44:45]
    v_pk_add_f32 v[30:31], v[30:31], v[46:47]
    s_waitcnt vmcnt(18)
    v_pk_add_f32 v[28:29], v[28:29], v[48:49]
    v_pk_add_f32 v[30:31], v[30:31], v[50:51]
    v_pk_add_f32 v[28:29], v[28:29], v[52:53]
    v_pk_add_f32 v[30:31], v[30:31], v[54:55]
    v_pk_add_f32 v[28:29], v[28:29], v[56:57]
    v_pk_add_f32 v[30:31], v[30:31], v[58:59]
    v_pk_add_f32 v[28:29], v[28:29], v[60:61]
    v_pk_add_f32 v[30:31], v[30:31], v[62:63]
    s_waitcnt vmcnt(14)
    v_pk_add_f32 v[28:29], v[28:29], v[64:65]
    v_pk_add_f32 v[30:31], v[30:31], v[66:67]
    v_pk_add_f32 v[28:29], v[28:29], v[68:69]
    v_pk_add_f32 v[30:31], v[30:31], v[70:71]
    v_pk_add_f32 v[28:29], v[28:29], v[72:73]
    v_pk_add_f32 v[30:31], v[30:31], v[74:75]
    v_pk_add_f32 v[28:29], v[28:29], v[76:77]
    v_pk_add_f32 v[30:31], v[30:31], v[78:79]
    s_waitcnt vmcnt(10)
    v_pk_add_f32 v[28:29], v[28:29], v[80:81]
    v_pk_add_f32 v[30:31], v[30:31], v[82:83]
    v_pk_add_f32 v[28:29], v[28:29], v[84:85]
    v_pk_add_f32 v[30:31], v[30:31], v[86:87]
    v_pk_add_f32 v[28:29], v[28:29], v[88:89]
    v_pk_add_f32 v[30:31], v[30:31], v[90:91]
    v_pk_add_f32 v[28:29], v[28:29], v[92:93]
    v_pk_add_f32 v[30:31], v[30:31], v[94:95]
    s_waitcnt vmcnt(6)
    v_pk_add_f32 v[28:29], v[28:29], v[96:97]
    v_pk_add_f32 v[30:31], v[30:31], v[98:99]
    v_pk_add_f32 v[28:29], v[28:29], v[100:101]
    v_pk_add_f32 v[30:31], v[30:31], v[102:103]
    v_pk_add_f32 v[28:29], v[28:29], v[104:105]
    v_pk_add_f32 v[30:31], v[30:31], v[106:107]
    v_pk_add_f32 v[28:29], v[28:29], v[108:109]
    v_pk_add_f32 v[30:31], v[30:31], v[110:111]
    s_waitcnt vmcnt(2)
    v_pk_add_f32 v[28:29], v[28:29], v[112:113]
    v_pk_add_f32 v[30:31], v[30:31], v[114:115]
    v_pk_add_f32 v[28:29], v[28:29], v[116:117]
    v_pk_add_f32 v[30:31], v[30:31], v[118:119]
    v_pk_add_f32 v[28:29], v[28:29], v[120:121]
    v_pk_add_f32 v[30:31], v[30:31], v[122:123]
    v_pk_add_f32 v[28:29], v[28:29], v[124:125]
    v_pk_add_f32 v[30:31], v[30:31], v[126:127]
    s_waitcnt vmcnt(0)
    v_pk_add_f32 v[28:29], v[28:29], v[128:129]
    v_pk_add_f32 v[30:31], v[30:31], v[130:131]
    v_pk_add_f32 v[28:29], v[28:29], v[132:133]
    v_pk_add_f32 v[30:31], v[30:31], v[134:135]
    v_mov_b32 v32, v28
    v_mov_b32 v33, v29
    v_mov_b32 v34, v30
    v_mov_b32 v35, v31
    s_nop 1
    v_permlane32_swap_b32 v32, v28
    v_permlane32_swap_b32 v33, v29
    v_permlane32_swap_b32 v34, v30
    v_permlane32_swap_b32 v35, v31
    s_nop 1
    v_add_f32 v28, v28, v32
    v_add_f32 v29, v29, v33
    v_add_f32 v30, v30, v34
    v_add_f32 v31, v31, v35
    v_mov_b32 v32, v28
    v_mov_b32 v33, v29
    v_mov_b32 v34, v30
    v_mov_b32 v35, v31
    s_nop 1
    v_permlane16_swap_b32 v32, v28
    v_permlane16_swap_b32 v33, v29
    v_permlane16_swap_b32 v34, v30
    v_permlane16_swap_b32 v35, v31
    s_nop 1
    v_add_f32 v28, v28, v32
    v_add_f32 v29, v29, v33
    v_add_f32 v30, v30, v34
    v_add_f32 v31, v31, v35
    v_cvt_pk_bf16_f32 v28, v28, v28
    v_and_b32 v28, 0xffff0000, v28
    v_cvt_pk_bf16_f32 v29, v29, v29
    v_and_b32 v29, 0xffff0000, v29
    v_cvt_pk_bf16_f32 v30, v30, v30
    v_and_b32 v30, 0xffff0000, v30
    v_cvt_pk_bf16_f32 v31, v31, v31
    v_and_b32 v31, 0xffff0000, v31
    v_mul_f32 v28, v5, v28
    v_mul_f32 v29, v5, v29
    v_mul_f32 v30, v5, v30
    v_mul_f32 v31, v5, v31
    v_cvt_pk_bf16_f32 v28, v28, v28
    v_and_b32 v28, 0xffff0000, v28
    v_cvt_pk_bf16_f32 v29, v29, v29
    v_and_b32 v29, 0xffff0000, v29
    v_cvt_pk_bf16_f32 v30, v30, v30
    v_and_b32 v30, 0xffff0000, v30
    v_cvt_pk_bf16_f32 v31, v31, v31
    v_and_b32 v31, 0xffff0000, v31
    s_lshl_b32 s29, s58, 8
    v_add_u32 v4, s29, v3
    ds_write_b128 v4, v[28:31]
    s_cmp_lg_u32 s66, 0
    s_waitcnt lgkmcnt(0)
    s_cbranch_scc1 L3_w9_tok
    s_branch L3_sv_end
L_end:
    s_endpgm
.section .rodata,"a"
.p2align 6
.amdhsa_kernel parallel_sum__softmax_full_mha__moe_arch_mod__prompt_kernel
  .amdhsa_next_free_vgpr 168
  .amdhsa_next_free_sgpr 80
  .amdhsa_accum_offset 168
  .amdhsa_group_segment_fixed_size 0
  .amdhsa_kernarg_size 88
  .amdhsa_user_sgpr_count 2
  .amdhsa_user_sgpr_kernarg_segment_ptr 1
  .amdhsa_system_sgpr_workgroup_id_x 1
  .amdhsa_float_denorm_mode_32 3
.end_amdhsa_kernel
```
